```python
import torch

def _softmax(x, axis=-1):
    return torch.softmax(x, dim=axis)
def _gelu(x):
    return torch.nn.functional.gelu(x, approximate="tanh")
def _silu(x):
    return torch.nn.functional.silu(x)
def _sigmoid(x):
    return torch.sigmoid(x)
def _layernorm(x, axis=-1, eps=1e-5):
    m = x.mean(dim=axis, keepdim=True)
    v = x.var(dim=axis, keepdim=True, unbiased=False)
    return (x - m) / torch.sqrt(v + eps)
def _scatter_add(tgt, idx, src, axis=0):
    return tgt.clone().index_add_(axis, idx, src)
def _segment_sum(src, seg, n):
    out = torch.zeros((n,) + src.shape[1:], dtype=src.dtype)
    return out.index_add_(0, seg, src)
def _pad(x, pw):
    flat = tuple(v for pair in reversed(pw) for v in pair)
    return torch.nn.functional.pad(x, flat)

kernel_name = 'gated_mix__spectral_gfnet__swiglu_ffn__prompt'

def setup_inputs():

    _w = (lambda a: (lambda t: t.to(torch.bfloat16) if t.is_floating_point() else t)(torch.as_tensor(a)))
    def _A_setup():
        B, S, D = 1, 2048, 448
        Df = D // 2 + 1
        return {
            "x": _w((lambda *s: torch.randn(*s, dtype=torch.bfloat16) * 0.05)(B, S, D)),
            "w_r": _w((lambda *s: torch.randn(*s, dtype=torch.bfloat16) * 0.8)(S, Df) * 0.02),
            "w_i": _w((lambda *s: torch.randn(*s, dtype=torch.bfloat16) * 0.8)(S, Df) * 0.02),
        }
    _A_in = _A_setup()

    def _B_setup():
        B, S, D, F = 1, 2048, 448, 1792
        return {
            "x": _w((lambda *s: torch.randn(*s, dtype=torch.bfloat16) * 0.05)(B, S, D)),
            "w_gate": _w((lambda *s: torch.randn(*s, dtype=torch.bfloat16) * 0.05)(D, F)),
            "w_up": _w((lambda *s: torch.randn(*s, dtype=torch.bfloat16) * 0.05)(D, F)),
            "w_down": _w((lambda *s: torch.randn(*s, dtype=torch.bfloat16) * 0.05)(F, D)),
        }
    _B_in = _B_setup()

    return {
        "A_x": _A_in["x"],
        "A_w_r": _A_in["w_r"],
        "A_w_i": _A_in["w_i"],
        "B_x": _B_in["x"],
        "B_w_gate": _B_in["w_gate"],
        "B_w_up": _B_in["w_up"],
        "B_w_down": _B_in["w_down"],
        "gate_w": _w((lambda *s: torch.randn(*s, dtype=torch.bfloat16) * 0.05)(448) * 16.0),
    }

def reference(A_x, A_w_r, A_w_i, B_x, B_w_gate, B_w_up, B_w_down, gate_w):
    def _A_ref(x, w_r, w_i):
        B, S, D = x.shape
        X = (lambda x, axes=(-2,-1): torch.fft.rfft2(x.float(), dim=axes))(x, axes=(-2, -1))
        W = w_r + 1j * w_i
        X = X * W
        y = (lambda x, s, axes=(-2,-1): torch.fft.irfft2(x, s=s, dim=axes).to(torch.bfloat16))(X, (S, D), axes=(-2, -1))
        return y

    def _B_ref(x, w_gate, w_up, w_down):
        g = _silu(x @ w_gate)
        u = x @ w_up
        return (g * u) @ w_down

    x = A_x
    g = _sigmoid((x * gate_w).sum(-1, keepdims=True))
    a = _A_ref(x, A_w_r, A_w_i)
    b = _B_ref(x, B_w_gate, B_w_up, B_w_down)
    return g * a + (1 - g) * b
```

```asm
; @launch grid=(256,1,1) block=(256,1,1) lds=163840
.amdgcn_target "amdgcn-amd-amdhsa--gfx950"
.text
.p2align 12
.globl gated_mix__spectral_gfnet__swiglu_ffn__prompt_kernel
.p2align 8
.type gated_mix__spectral_gfnet__swiglu_ffn__prompt_kernel,@function
gated_mix__spectral_gfnet__swiglu_ffn__prompt_kernel:
s_load_dwordx2 s[4:5], s[0:1], 0
s_load_dwordx2 s[8:9], s[0:1], 32
s_load_dwordx2 s[12:13], s[0:1], 40
v_lshrrev_b32 v2, 6, v0
v_mul_u32_u24 v3, 40, v0
v_and_b32 v0, 63, v0
s_lshr_b32 s41, s2, 3
v_readfirstlane_b32 s32, v2
s_and_b32 s40, s2, 7
s_cmp_lt_u32 s41, 28
s_cbranch_scc1 L_main
s_getpc_b64 s[42:43]
L_pc:
s_and_b32 s47, s41, 3
s_mul_i32 s47, s47, 10240
v_add_u32 v3, s47, v3
v_min_u32 v3, L_codeend-L_pc-4, v3
global_load_dword v255, v3, s[42:43]
L_main:
s_load_dwordx4 s[60:63], s[0:1], 8
s_load_dwordx4 s[16:19], s[0:1], 48
s_load_dwordx4 s[28:31], s[0:1], 72
s_load_dwordx2 s[24:25], s[0:1], 64
s_and_b32 s42, s41, 3
s_lshr_b32 s36, s41, 2
s_lshr_b32 s43, s40, 1
s_xor_b32 s69, s42, s36
s_and_b32 s69, s69, 1
s_xor_b32 s47, s40, s43
s_and_b32 s47, s47, 1
s_lshl1_add_u32 s69, s47, s69
s_lshl_b32 s69, s69, 2
s_lshr_b32 s69, 0x5230, s69
s_and_b32 s69, s69, 7
s_lshl_b32 s48, s69, 7
s_lshl2_add_u32 s47, s43, s32
s_lshl4_add_u32 s47, s47, s42
s_mulk_i32 s47, 7168
v_lshrrev_b32 v168, 3, v0
v_mul_u32_u24 v168, 896, v168
v_add_u32 v168, s47, v168
v_and_b32 v169, 7, v0
v_lshrrev_b32 v170, 4, v0
v_xor_b32 v169, v169, v170
v_lshl_add_u32 v2, v169, 4, v168
v_xor_b32 v3, 64, v2
v_add_u32 v4, 55296, v2
v_add_u32 v5, 82944, v3
v_add_u32 v3, 27648, v3
s_lshl_b32 s39, s32, 14
s_add_u32 s39, s39, 83200
s_mov_b32 s6, 1835008
s_mov_b32 s7, 0x20000
s_mov_b32 m0, s39
s_and_b32 s34, s40, 1
s_mulk_i32 s34, 7
s_add_u32 s34, s34, s36
v_lshrrev_b32 v172, 5, v0
v_and_b32 v174, 3, v0
v_lshl_add_u32 v170, v172, 2, v174
v_lshlrev_b32 v170, 4, v170
v_bfe_u32 v171, v0, 2, 3
v_lshl_add_u32 v168, s32, 3, v171
v_mul_u32_u24 v168, 3584, v168
s_lshl_b32 s47, s34, 8
v_add3_u32 v14, v168, v170, s47
v_add_u32 v15, 114688, v14
s_and_b32 s47, s32, 2
s_mul_i32 s38, s32, 1056
s_lshl_b32 s47, s47, 10
s_add_u32 s38, s38, s47
s_mul_i32 s55, s69, 229376
s_mov_b32 s10, 1605632
s_mov_b32 s11, 0x20000
s_mov_b32 s14, 1607712
s_mov_b32 s15, 0x20000
s_cmp_ge_u32 s41, 28
s_cbranch_scc1 L_auxh
s_waitcnt lgkmcnt(0)
buffer_load_dwordx4 v2, s[4:7], s48 offen offset:0 lds
buffer_load_dwordx4 v3, s[4:7], s48 offen offset:1024 lds
buffer_load_dwordx4 v4, s[4:7], s48 offen offset:2048 lds
buffer_load_dwordx4 v5, s[4:7], s48 offen offset:3072 lds
s_sub_u32 s12, s12, 2080
s_subb_u32 s13, s13, 0
s_add_u32 m0, s38, 0
s_nop 0
buffer_load_dwordx4 v14, s[8:11], s55 offen offset:0 lds
buffer_load_dwordx4 v14, s[12:15], s55 offen offset:2080 lds
s_add_u32 m0, s38, 8320
s_nop 0
buffer_load_dwordx4 v15, s[8:11], s55 offen offset:0 lds
buffer_load_dwordx4 v15, s[12:15], s55 offen offset:2080 lds
s_add_u32 s70, s69, 1
s_cmp_eq_u32 s70, 7
s_cselect_b32 s70, 0, s70
s_lshl_b32 s49, s70, 7
s_mul_i32 s56, s70, 229376
s_add_u32 m0, s39, 4096
s_nop 0
buffer_load_dwordx4 v2, s[4:7], s49 offen offset:0 lds
buffer_load_dwordx4 v3, s[4:7], s49 offen offset:1024 lds
buffer_load_dwordx4 v4, s[4:7], s49 offen offset:2048 lds
buffer_load_dwordx4 v5, s[4:7], s49 offen offset:3072 lds
s_mov_b64 s[20:21], s[30:31]
s_branch L_main2
L_auxh:
s_cmp_ge_u32 s2, 256
s_cbranch_scc1 L_end
s_lshl2_add_u32 s35, s40, s41
s_sub_u32 s35, s35, 28
s_mov_b32 s36, s40
v_lshlrev_b32 v1, 4, v0
s_lshl_b32 s40, s32, 10
v_add_u32 v2, s40, v1
s_waitcnt lgkmcnt(0)
s_mov_b64 s[64:65], s[62:63]
s_mov_b64 s[56:57], s[18:19]
s_mov_b64 s[20:21], s[30:31]
s_mov_b32 s22, 15998976
s_mov_b32 s23, 0x20000
s_mov_b32 s62, 921600
s_mov_b32 s63, 0x20000
s_mov_b32 s66, 921600
s_mov_b32 s67, 0x20000
v_mov_b32 v4, 0
v_mov_b32 v5, 0
v_mov_b32 v6, 0
v_mov_b32 v7, 0
s_mul_i32 s41, s35, 8192
buffer_store_dwordx4 v[4:7], v2, s[20:23], s41 offen sc1
s_addk_i32 s41, 4096
buffer_store_dwordx4 v[4:7], v2, s[20:23], s41 offen sc1
s_addk_i32 s41, 4096
s_lshr_b32 s33, s35, 3
s_and_b32 s34, s35, 7
s_lshl_b32 s41, s33, 6
s_add_u32 s41, s41, s34
s_mul_i32 s41, s41, 3600
v_lshrrev_b32 v16, 5, v0
v_lshl_add_u32 v17, s32, 1, v16
v_mul_u32_u24 v17, 28, v17
v_and_b32 v18, 31, v0
v_add3_u32 v17, v17, v18, v16
v_add_u32 v17, -1, v17
v_max_i32 v17, 0, v17
v_lshlrev_b32 v17, 4, v17
s_mul_i32 s42, s32, 1120
s_add_u32 m0, s42, 0
s_nop 0
buffer_load_dwordx4 v17, s[60:63], s41 offen lds
s_add_u32 m0, s42, 35840
s_nop 0
buffer_load_dwordx4 v17, s[64:67], s41 offen lds
s_add_u32 s41, s41, 28800
s_add_u32 m0, s42, 4480
s_nop 0
buffer_load_dwordx4 v17, s[60:63], s41 offen lds
s_add_u32 m0, s42, 40320
s_nop 0
buffer_load_dwordx4 v17, s[64:67], s41 offen lds
s_add_u32 s41, s41, 28800
s_add_u32 m0, s42, 8960
s_nop 0
buffer_load_dwordx4 v17, s[60:63], s41 offen lds
s_add_u32 m0, s42, 44800
s_nop 0
buffer_load_dwordx4 v17, s[64:67], s41 offen lds
s_add_u32 s41, s41, 28800
s_add_u32 m0, s42, 13440
s_nop 0
buffer_load_dwordx4 v17, s[60:63], s41 offen lds
s_add_u32 m0, s42, 49280
s_nop 0
buffer_load_dwordx4 v17, s[64:67], s41 offen lds
s_add_u32 s41, s41, 28800
s_add_u32 m0, s42, 17920
s_nop 0
buffer_load_dwordx4 v17, s[60:63], s41 offen lds
s_add_u32 m0, s42, 53760
s_nop 0
buffer_load_dwordx4 v17, s[64:67], s41 offen lds
s_add_u32 s41, s41, 28800
s_add_u32 m0, s42, 22400
s_nop 0
buffer_load_dwordx4 v17, s[60:63], s41 offen lds
s_add_u32 m0, s42, 58240
s_nop 0
buffer_load_dwordx4 v17, s[64:67], s41 offen lds
s_add_u32 s41, s41, 28800
s_add_u32 m0, s42, 26880
s_nop 0
buffer_load_dwordx4 v17, s[60:63], s41 offen lds
s_add_u32 m0, s42, 62720
s_nop 0
buffer_load_dwordx4 v17, s[64:67], s41 offen lds
s_add_u32 s41, s41, 28800
s_add_u32 m0, s42, 31360
s_nop 0
buffer_load_dwordx4 v17, s[60:63], s41 offen lds
s_add_u32 m0, s42, 67200
s_nop 0
buffer_load_dwordx4 v17, s[64:67], s41 offen lds
s_add_u32 s41, s41, 28800
s_lshl2_add_u32 s47, s35, s32
s_lshr_b32 s42, s36, 1
s_and_b32 s47, s47, 15
s_lshl4_add_u32 s47, s42, s47
s_mul_i32 s42, s47, 3584
s_and_b32 s43, s36, 1
s_mul_i32 s41, s43, 1792
s_add_u32 s42, s42, s41
v_lshrrev_b32 v4, 3, v0
v_mul_u32_u24 v4, 229376, v4
v_and_b32 v5, 7, v0
v_min_u32 v5, 6, v5
v_lshl_add_u32 v4, v5, 8, v4
v_add_u32 v13, s42, v4
s_lshl_b32 s43, s43, 6
s_add_u32 s47, s47, s43
s_mul_i32 s47, s47, 49
v_add_u32 v4, s47, v0
v_mul_u32_u24 v5, 9363, v4
v_lshrrev_b32 v5, 22, v5
v_mul_u32_u24 v5, 57344, v5
v_lshl_add_u32 v14, v4, 7, v5
s_mov_b32 s14, 1605632
s_mov_b32 s18, 1605632
s_mov_b32 s19, 0x20000
s_mov_b32 s58, 896
s_mov_b32 s59, 0x20000
s_mov_b32 s30, 256
s_mov_b32 s31, 0x20000
s_lshl_b32 s41, s35, 3
v_mov_b32 v8, 1
v_mov_b32 v9, s40
s_waitcnt vmcnt(16)
s_barrier
s_mov_b64 exec, 1
buffer_store_dword v8, v9, s[28:31], s41 offen sc1
s_mov_b64 exec, -1
s_mov_b32 exec_lo, 0xffffffff
s_mov_b32 exec_hi, 0xffffff
buffer_load_dword v15, v13, s[8:11], 0 offen offset:128
buffer_load_dword v15, v13, s[12:15], 0 offen offset:128
s_mov_b64 exec, -1
s_mov_b32 s41, 0
s_mov_b32 exec_lo, 0xffffffff
s_mov_b32 exec_hi, 0x1ffff
buffer_load_dword v15, v14, s[16:19], s41 offen
s_mov_b64 exec, -1
s_mov_b32 s41, 57344
s_mov_b32 exec_lo, 0xffffffff
s_mov_b32 exec_hi, 0x1ffff
buffer_load_dword v15, v14, s[16:19], s41 offen
s_mov_b64 exec, -1
s_branch L_aux
L_main2:
s_lshl2_add_u32 s33, s43, s42
s_add_u32 s70, s70, 1
s_cmp_eq_u32 s70, 7
s_cselect_b32 s70, 0, s70
s_lshl_b32 s50, s70, 7
s_mul_i32 s57, s70, 229376
s_add_u32 s70, s70, 1
s_cmp_eq_u32 s70, 7
s_cselect_b32 s70, 0, s70
s_lshl_b32 s51, s70, 7
s_mul_i32 s58, s70, 229376
s_add_u32 s70, s70, 1
s_cmp_eq_u32 s70, 7
s_cselect_b32 s70, 0, s70
s_lshl_b32 s52, s70, 7
s_mul_i32 s59, s70, 229376
s_add_u32 s70, s70, 1
s_cmp_eq_u32 s70, 7
s_cselect_b32 s70, 0, s70
s_lshl_b32 s53, s70, 7
s_mul_i32 s60, s70, 229376
s_add_u32 s70, s70, 1
s_cmp_eq_u32 s70, 7
s_cselect_b32 s70, 0, s70
s_lshl_b32 s54, s70, 7
s_mul_i32 s61, s70, 229376
s_and_b32 s35, s40, 1
s_lshl1_add_u32 s35, s33, s35
s_mul_i32 s37, s40, 28
s_add_u32 s37, s37, s41
s_movk_i32 s46, 0x7f
v_lshlrev_b32 v1, 4, v0
v_and_b32 v168, 15, v0
v_lshrrev_b32 v175, 4, v0
v_bfe_u32 v169, v0, 1, 3
v_xor_b32 v169, v169, v175
v_lshlrev_b32 v169, 4, v169
v_lshl_add_u32 v169, v168, 7, v169
v_xor_b32 v173, 64, v169
s_xor_b32 s40, s32, 1
s_lshl_b32 s40, s40, 14
s_add_u32 s40, s40, 83200
v_add_u32 v6, s39, v169
v_add_u32 v7, s39, v173
v_add_u32 v8, s40, v169
v_add_u32 v9, s40, v173
v_bfe_u32 v169, v0, 4, 1
v_bfe_u32 v173, v0, 2, 2
s_and_b32 s40, s32, 1
s_lshl_b32 s41, s40, 9
v_mul_u32_u24 v16, 1056, v169
v_mul_u32_u24 v17, 4160, v172
v_add3_u32 v16, v16, v17, s41
v_lshl_add_u32 v16, v173, 6, v16
v_lshl_add_u32 v16, v174, 3, v16
v_add_u32 v17, 66560, v16
s_lshl1_add_u32 s47, s34, s40
v_lshl_add_u32 v215, s47, 4, v168
v_lshrrev_b32 v216, 1, v215
v_and_b32 v217, 1, v215
v_cmp_eq_u32 vcc, 1, v215
v_mov_b32 v214, 224
s_mov_b32 s47, 9586981
v_cndmask_b32 v216, v216, v214, vcc
v_cndmask_b32 v217, v217, 0, vcc
v_mul_lo_u32 v213, v216, s47
s_and_b32 s47, s32, 2
s_lshl2_add_u32 s40, s47, s40
s_add_u32 s47, s47, s69
s_lshl_b32 s47, s47, 6
v_lshl_add_u32 v216, v175, 3, s47
v_mul_lo_u32 v212, v216, v213
v_lshl_add_u32 v212, v217, 30, v212
v_lshlrev_b32 v216, 5, v213
v_add_u32 v24, 148736, v1
v_lshl_add_u32 v217, s40, 10, v24
v_alignbit_b32 v214, s46, v216, 9
v_cos_f32 v208, v214
v_alignbit_b32 v215, s46, v213, 9
v_cos_f32 v218, v215
v_alignbit_b32 v214, s46, v212, 9
v_cos_f32 v192, v214
v_add_u32 v215, v212, v213
v_alignbit_b32 v215, s46, v215, 9
v_cos_f32 v193, v215
v_add_u32 v212, v212, v216
v_add_f32 v218, v218, v218
v_mul_f32 v209, -2.0, v208
v_add_f32 v208, v208, v208
v_alignbit_b32 v214, s46, v212, 9
v_cos_f32 v200, v214
v_add_u32 v215, v212, v213
v_alignbit_b32 v215, s46, v215, 9
v_cos_f32 v201, v215
v_fma_f32 v194, v218, v193, -v192
v_fma_f32 v202, v218, v201, -v200
v_fma_f32 v195, v218, v194, -v193
v_fma_f32 v203, v218, v202, -v201
v_fma_f32 v196, v218, v195, -v194
v_fma_f32 v204, v218, v203, -v202
v_fma_f32 v197, v218, v196, -v195
v_fma_f32 v205, v218, v204, -v203
v_fma_f32 v198, v218, v197, -v196
v_fma_f32 v206, v218, v205, -v204
v_fma_f32 v199, v218, v198, -v197
v_fma_f32 v207, v218, v206, -v205
v_cvt_pk_bf16_f32 v48, v192, v193
v_cvt_pk_bf16_f32 v49, v194, v195
v_cvt_pk_bf16_f32 v50, v196, v197
v_cvt_pk_bf16_f32 v51, v198, v199
v_cvt_pk_bf16_f32 v52, v200, v201
v_cvt_pk_bf16_f32 v53, v202, v203
v_cvt_pk_bf16_f32 v54, v204, v205
v_cvt_pk_bf16_f32 v55, v206, v207
v_fmac_f32 v192, v209, v200
v_fmac_f32 v193, v209, v201
v_fmac_f32 v194, v209, v202
v_fmac_f32 v195, v209, v203
v_fmac_f32 v196, v209, v204
v_fmac_f32 v197, v209, v205
v_fmac_f32 v198, v209, v206
v_fmac_f32 v199, v209, v207
v_cvt_pk_bf16_f32 v56, -v192, -v193
v_cvt_pk_bf16_f32 v57, -v194, -v195
v_cvt_pk_bf16_f32 v58, -v196, -v197
v_cvt_pk_bf16_f32 v59, -v198, -v199
v_fmac_f32 v200, v208, v192
v_fmac_f32 v201, v208, v193
v_fmac_f32 v202, v208, v194
v_fmac_f32 v203, v208, v195
v_fmac_f32 v204, v208, v196
v_fmac_f32 v205, v208, v197
v_fmac_f32 v206, v208, v198
v_fmac_f32 v207, v208, v199
v_cvt_pk_bf16_f32 v60, -v200, -v201
v_cvt_pk_bf16_f32 v61, -v202, -v203
v_cvt_pk_bf16_f32 v62, -v204, -v205
v_cvt_pk_bf16_f32 v63, -v206, -v207
s_mov_b64 exec, 0
s_cmp_eq_u32 s32, 0
s_cbranch_scc1 L_pad0
s_cmp_eq_u32 s32, 1
s_cbranch_scc1 L_pad1
s_cmp_eq_u32 s32, 2
s_cbranch_scc1 L_pad2
s_branch L_pad3
L_padret:
s_mov_b64 exec, -1
s_branch L_body
L_slow_go:
s_mov_b32 s77, 0
L_spin_go:
buffer_load_dword v28, v30, s[28:31], 0 offen sc1
s_waitcnt vmcnt(0)
v_cmp_ne_u32 vcc, 1, v28
s_cbranch_vccz L_back_go
s_sleep 8
s_add_u32 s77, s77, 1
s_cmp_lt_u32 s77, 200000
s_cbranch_scc1 L_spin_go
s_endpgm
L_slow_p1:
s_mov_b32 s77, 0
L_spin_p1:
buffer_load_dword v29, v27, s[20:23], 0 offen sc1
s_waitcnt vmcnt(0)
v_cmp_ne_u32 vcc, 1, v29
s_cbranch_vccz L_back_p1
s_sleep 8
s_add_u32 s77, s77, 1
s_cmp_lt_u32 s77, 200000
s_cbranch_scc1 L_spin_p1
s_endpgm
L_slow_pW:
s_mov_b32 s77, 0
L_spin_pW:
buffer_load_dword v29, v31, s[20:23], 0 offen sc1
s_waitcnt vmcnt(0)
v_cmp_ne_u32 vcc, 1, v29
s_cbranch_vccz L_back_pW
s_sleep 8
s_add_u32 s77, s77, 1
s_cmp_lt_u32 s77, 200000
s_cbranch_scc1 L_spin_pW
s_endpgm
L_slow_pA:
s_mov_b32 s77, 0
L_spin_pA:
buffer_load_dword v29, v4, s[20:23], s50 offen sc1
s_waitcnt vmcnt(0)
v_cmp_ne_u32 vcc, 1, v29
s_cbranch_vccz L_back_pA
s_sleep 8
s_add_u32 s77, s77, 1
s_cmp_lt_u32 s77, 200000
s_cbranch_scc1 L_spin_pA
s_endpgm
L_slow_pB:
s_mov_b32 s77, 0
L_spin_pB:
buffer_load_dword v29, v4, s[20:23], s50 offen sc1
s_waitcnt vmcnt(0)
v_cmp_ne_u32 vcc, 1, v29
s_cbranch_vccz L_back_pB
s_sleep 8
s_add_u32 s77, s77, 1
s_cmp_lt_u32 s77, 200000
s_cbranch_scc1 L_spin_pB
s_endpgm
L_slow_pZ:
s_mov_b32 s77, 0
L_spin_pZ:
buffer_load_dword v29, v27, s[20:23], 0 offen sc1
s_waitcnt vmcnt(0)
v_cmp_ne_u32 vcc, 1, v29
s_cbranch_vccz L_back_pZ
s_sleep 8
s_add_u32 s77, s77, 1
s_cmp_lt_u32 s77, 200000
s_cbranch_scc1 L_spin_pZ
s_endpgm
L_slow_pP:
s_mov_b32 s77, 0
L_spin_pP:
buffer_load_dwordx4 v[96:99], v1, s[20:23], s75 offen offset:0 sc1
buffer_load_dwordx4 v[100:103], v1, s[20:23], s75 offen offset:1024 sc1
buffer_load_dword v8, v7, s[20:23], s78 offen offset:0 sc1
buffer_load_dword v9, v7, s[20:23], s78 offen offset:64 sc1
s_waitcnt vmcnt(0)
v_min_u32 v29, v8, v9
v_add_u32 v29, -1, v29
v_sub_f32 v14, 1.0, v8
v_sub_f32 v15, 1.0, v9
v_cvt_pk_bf16_f32 v14, 0, v14
v_cvt_pk_bf16_f32 v15, 0, v15
v_max3_u32 v29, v96, v100, v29
v_cmp_eq_u32 vcc, -1, v29
s_cbranch_vccz L_back_pP
s_sleep 1
s_add_u32 s77, s77, 1
s_cmp_lt_u32 s77, 200000
s_cbranch_scc1 L_spin_pP
s_endpgm
L_slow_goa:
s_mov_b32 s77, 0
L_spin_goa:
buffer_load_dword v28, v30, s[28:31], 0 offen sc1
s_waitcnt vmcnt(0)
v_cmp_ne_u32 vcc, 1, v28
s_cbranch_vccz L_back_goa
s_sleep 8
s_add_u32 s77, s77, 1
s_cmp_lt_u32 s77, 200000
s_cbranch_scc1 L_spin_goa
s_endpgm
L_slow_p1a:
s_mov_b32 s77, 0
L_spin_p1a:
buffer_load_dword v29, v27, s[20:23], 0 offen sc1
s_waitcnt vmcnt(0)
v_cmp_ne_u32 vcc, 1, v29
s_cbranch_vccz L_back_p1a
s_sleep 12
s_add_u32 s77, s77, 1
s_cmp_lt_u32 s77, 200000
s_cbranch_scc1 L_spin_p1a
s_endpgm
.p2align 12
L_body:
s_cmp_ge_u32 s32, 2
ds_write_b128 v217, v[48:51] offset:0
ds_write_b128 v217, v[52:55] offset:2048
ds_write_b128 v217, v[56:59] offset:4096
s_cbranch_scc1 L_f2
ds_write_b128 v217, v[60:63] offset:6144
L_f2:
s_waitcnt lgkmcnt(0)
s_add_u32 m0, s38, 16640
s_nop 0
buffer_load_dwordx4 v14, s[8:11], s56 offen offset:0 lds
buffer_load_dwordx4 v14, s[12:15], s56 offen offset:2080 lds
s_add_u32 m0, s38, 24960
s_nop 0
buffer_load_dwordx4 v15, s[8:11], s56 offen offset:0 lds
buffer_load_dwordx4 v15, s[12:15], s56 offen offset:2080 lds
s_waitcnt lgkmcnt(0)
s_waitcnt vmcnt(10)
s_barrier
ds_read_b128 a[0:3], v6 offset:0
ds_read_b64_tr_b16 v[32:33], v16 offset:0
ds_read_b64_tr_b16 v[34:35], v16 offset:256
ds_read_b128 a[4:7], v6 offset:2048
ds_read_b128 a[8:11], v8 offset:0
ds_read_b128 a[12:15], v8 offset:2048
ds_read_b64_tr_b16 v[36:37], v16 offset:32
ds_read_b64_tr_b16 v[38:39], v16 offset:288
ds_read_b64_tr_b16 v[40:41], v16 offset:2080
ds_read_b64_tr_b16 v[42:43], v16 offset:2336
ds_read_b128 v[160:163], v24 offset:0
ds_read_b128 v[164:167], v24 offset:1024
s_waitcnt lgkmcnt(6)
v_mfma_f32_16x16x32_bf16 v[96:99], v[32:35], a[0:3], 0
s_mov_b32 s71, 0x36124925
ds_read_b64_tr_b16 v[44:45], v16 offset:2112
ds_read_b64_tr_b16 v[46:47], v16 offset:2368
s_cmp_eq_u32 s37, 0
s_cselect_b32 s71, 0x35924925, s71
s_lshl_b32 s75, s37, 31
s_or_b32 s71, s71, s75
s_mov_b32 s22, 15998976
s_mov_b32 s23, 0x20000
v_mfma_f32_16x16x32_bf16 v[112:115], v[32:35], a[4:7], 0
s_add_u32 m0, s39, 8192
ds_read_b128 a[16:19], v7 offset:0
ds_read_b128 a[20:23], v7 offset:2048
s_lshl3_add_u32 s75, s35, s36
s_lshl2_add_u32 s75, s75, s32
s_lshl_b32 s75, s75, 11
s_xor_b32 s74, s75, 0x10000
s_add_u32 s75, s75, 13901824
s_add_u32 s74, s74, 13901824
v_mfma_f32_16x16x32_bf16 v[128:131], v[32:35], a[8:11], 0
s_mov_b32 s18, 1605632
buffer_load_dwordx4 v2, s[4:7], s50 offen offset:0 lds
v_mov_b32 v232, -1
v_mov_b32 v233, -1
v_mov_b32 v234, -1
v_mov_b32 v235, -1
s_mov_b32 s19, 0x20000
s_mov_b32 s30, 256
s_mov_b32 s31, 0x20000
v_mfma_f32_16x16x32_bf16 v[144:147], v[32:35], a[12:15], 0
s_waitcnt lgkmcnt(8)
v_lshlrev_b32 v22, 5, v169
v_xor_b32 v23, v22, v170
v_mul_u32_u24 v18, 896, v171
s_lshl_b32 s47, s36, 7
v_add3_u32 v18, v18, v23, s47
v_add_u32 v19, 6144, v18
v_add_u32 v20, 12288, v18
v_add_u32 v21, 18432, v18
v_mfma_f32_16x16x32_bf16 v[148:151], v[36:39], a[12:15], 0
s_lshr_b32 s41, s32, 1
buffer_load_dwordx4 v3, s[4:7], s50 offen offset:1024 lds
v_lshl_add_u32 v22, v171, 6, v22
v_lshl_add_u32 v22, v174, 3, v22
v_lshl_add_u32 v23, v171, 12, v23
s_and_b32 s40, s32, 1
s_lshl4_add_u32 s40, s41, s40
s_lshl_b32 s40, s40, 5
v_lshl_add_u32 v10, v172, 10, v22
v_mfma_f32_16x16x32_bf16 v[132:135], v[36:39], a[8:11], 0
s_lshl_b32 s47, s41, 15
ds_read_b128 a[24:27], v9 offset:0
ds_read_b128 a[28:31], v9 offset:2048
v_xor_b32 v10, s40, v10
v_xor_b32 v11, 32, v10
v_xor_b32 v12, 0x200, v10
v_xor_b32 v13, 0x220, v10
s_add_u32 s47, s47, 83200
v_add_u32 v10, s47, v10
v_mfma_f32_16x16x32_bf16 v[116:119], v[36:39], a[4:7], 0
s_and_b32 s40, s35, 1
v_add_u32 v11, s47, v11
v_add_u32 v12, s47, v12
v_add_u32 v13, s47, v13
v_bfe_u32 v173, v0, 1, 1
v_lshlrev_b32 v25, 31, v173
v_or_b32 v25, 1.0, v25
v_and_b32 v30, 31, v0
v_lshlrev_b32 v30, 3, v30
v_mfma_f32_16x16x32_bf16 v[100:103], v[36:39], a[0:3], 0
s_waitcnt lgkmcnt(8)
buffer_load_dwordx4 v4, s[4:7], s50 offen offset:2048 lds
s_lshl_b32 s47, s42, 4
v_xor_b32 v173, s47, v170
v_lshl_add_u32 v26, v171, 14, v173
s_lshl_b32 s47, s34, 8
s_add_u32 s47, s47, s33
s_lshl2_add_u32 s47, s47, s32
s_lshl_b32 s47, s47, 7
v_mfma_f32_16x16x32_bf16 v[104:107], v[40:43], a[0:3], 0
s_add_u32 s47, s47, 1048576
v_add_u32 v26, s47, v26
s_lshl1_add_u32 s72, s40, s41
s_mul_i32 s40, s40, 28
s_add_u32 s41, s41, s40
s_mul_i32 s41, s41, 28672
s_and_b32 s42, s32, 1
s_mov_b32 s40, s42
s_sub_u32 s47, s40, 7
v_mfma_f32_16x16x32_bf16 v[120:123], v[40:43], a[4:7], 0
s_min_u32 s40, s40, s47
s_mul_i32 s47, s40, 114688
s_add_u32 s62, s47, s41
s_add_u32 s40, s40, 2
s_sub_u32 s47, s40, 7
s_min_u32 s40, s40, s47
s_mul_i32 s47, s40, 114688
s_add_u32 s63, s47, s41
s_add_u32 s40, s40, 2
v_mfma_f32_16x16x32_bf16 v[136:139], v[40:43], a[8:11], 0
s_sub_u32 s47, s40, 7
buffer_load_dwordx4 v5, s[4:7], s50 offen offset:3072 lds
s_min_u32 s40, s40, s47
s_mul_i32 s47, s40, 114688
s_add_u32 s64, s47, s41
s_add_u32 s40, s40, 2
s_sub_u32 s47, s40, 7
s_min_u32 s40, s40, s47
s_mul_i32 s47, s40, 114688
v_mfma_f32_16x16x32_bf16 v[152:155], v[40:43], a[12:15], 0
s_waitcnt lgkmcnt(4)
s_add_u32 s65, s47, s41
s_add_u32 s40, s40, 2
s_sub_u32 s47, s40, 7
s_min_u32 s40, s40, s47
s_mul_i32 s47, s40, 114688
s_add_u32 s41, s41, 57344
s_add_u32 s66, s47, s41
s_add_u32 s40, s40, 2
v_mfma_f32_16x16x32_bf16 v[156:159], v[44:47], a[12:15], 0
s_add_u32 m0, s38, 33280
s_sub_u32 s47, s40, 7
s_min_u32 s40, s40, s47
s_mul_i32 s47, s40, 114688
s_add_u32 s67, s47, s41
s_add_u32 s40, s40, 2
s_sub_u32 s47, s40, 7
s_min_u32 s40, s40, s47
s_mul_i32 s47, s40, 114688
v_mfma_f32_16x16x32_bf16 v[140:143], v[44:47], a[8:11], 0
s_add_u32 s68, s47, s41
buffer_load_dwordx4 v14, s[8:11], s57 offen offset:0 lds
s_mul_i32 s47, s42, 57344
s_add_u32 s65, s65, s47
s_movk_i32 s1, 8192
s_lshr_b32 s40, s32, 1
s_lshl1_add_u32 s40, s33, s40
s_mul_i32 s69, s40, 229376
s_and_b32 s41, s32, 1
v_mfma_f32_16x16x32_bf16 v[124:127], v[44:47], a[4:7], 0
s_waitcnt vmcnt(13)
s_barrier
v_mfma_f32_16x16x32_bf16 v[108:111], v[44:47], a[0:3], 0
ds_read_b64_tr_b16 v[32:33], v16 offset:8320
ds_read_b64_tr_b16 v[34:35], v16 offset:8576
s_lshl1_add_u32 s42, s34, s41
s_lshl_b32 s47, s42, 11
s_add_u32 s69, s69, s47
s_mul_i32 s41, s41, 57344
s_sub_u32 s3, s69, s41
s_add_u32 s69, s69, s41
v_mfma_f32_16x16x32_bf16 v[80:83], a[0:3], v[160:163], 0
s_add_u32 s69, s69, 6561792
ds_read_b64_tr_b16 v[36:37], v16 offset:8352
ds_read_b64_tr_b16 v[38:39], v16 offset:8608
s_add_u32 s3, s3, 6619136
s_and_b32 s41, s35, 1
s_lshl1_add_u32 s40, s40, s41
s_and_b32 s41, s32, 1
s_lshl1_add_u32 s40, s40, s41
s_lshl_b32 s40, s40, 7
v_mfma_f32_16x16x32_bf16 v[84:87], a[4:7], v[160:163], 0
s_lshl2_add_u32 s40, s36, s40
ds_read_b64_tr_b16 v[40:41], v16 offset:10400
ds_read_b64_tr_b16 v[42:43], v16 offset:10656
s_add_u32 s79, s40, 131072
s_mov_b32 s44, 0xbfb8aa3b
s_mov_b32 s45, 0xbfb8aa3b
s_lshl4_add_u32 s0, s34, s33
s_lshl2_add_u32 s0, s0, s32
s_lshl_b32 s0, s0, 7
v_mfma_f32_16x16x32_bf16 v[88:91], a[0:3], v[164:167], 0
s_mov_b32 s26, 1835008
buffer_load_dwordx4 v14, s[12:15], s57 offen offset:2080 lds
s_mov_b32 s27, 0x20000
s_and_b32 s40, s35, 1
s_xor_b32 s40, s40, 1
s_mul_i32 s40, s40, 7
s_add_u32 s40, s40, s36
s_lshl4_add_u32 s40, s40, s33
s_lshl2_add_u32 s40, s40, s32
v_mfma_f32_16x16x32_bf16 v[92:95], a[4:7], v[164:167], 0
s_waitcnt lgkmcnt(4)
s_lshr_b32 s41, s37, 4
s_cmp_eq_u32 s41, 14
s_cselect_b32 s41, 0, s41
s_lshl2_add_u32 s41, s41, s32
s_lshl_b32 s41, s41, 4
s_lshl_b32 s42, s32, 1
v_add_u32 v27, s41, v0
v_bfe_u32 v246, v0, 1, 2
v_mfma_f32_16x16x32_bf16 v[96:99], v[32:35], a[16:19], v[96:99]
ds_read_b64_tr_b16 v[44:45], v16 offset:10432
ds_read_b64_tr_b16 v[46:47], v16 offset:10688
v_and_b32 v247, 1, v0
v_lshl_add_u32 v246, v246, 3, v247
v_add_u32 v246, s42, v246
v_add_u32 v246, 896, v246
v_lshlrev_b32 v31, 7, v246
v_mov_b32 v246, s40
v_mfma_f32_16x16x32_bf16 v[112:115], v[32:35], a[20:23], v[112:115]
s_add_u32 m0, s38, 41600
ds_read_b128 v[248:251], v24 offset:2048
ds_read_b128 v[252:255], v24 offset:3072
v_subrev_u32 v247, 16, v0
v_ashrrev_i32 v247, 31, v247
v_bfi_b32 v27, v247, v27, v246
v_lshlrev_b32 v27, 7, v27
v_and_b32 v247, 3, v0
v_mul_u32_u24 v240, 528, v247
v_mfma_f32_16x16x32_bf16 v[128:131], v[32:35], a[24:27], v[128:131]
buffer_load_dwordx4 v15, s[8:11], s57 offen offset:0 lds
v_lshrrev_b32 v246, 4, v0
v_lshl_add_u32 v240, v246, 7, v240
v_bfe_u32 v246, v0, 2, 1
v_lshl_add_u32 v240, v246, 6, v240
v_and_b32 v246, 8, v0
v_add_u32 v240, v246, v240
v_add_u32 v240, 148736, v240
v_mfma_f32_16x16x32_bf16 v[144:147], v[32:35], a[28:31], v[144:147]
s_waitcnt vmcnt(7) lgkmcnt(6)
s_barrier
v_mfma_f32_16x16x32_bf16 v[148:151], v[36:39], a[28:31], v[148:151]
ds_read_b64_tr_b16 v[32:33], v16 offset:16640
ds_read_b64_tr_b16 v[34:35], v16 offset:16896
v_xor_b32 v241, 16, v240
v_xor_b32 v242, 32, v240
v_xor_b32 v243, 48, v240
v_lshrrev_b32 v246, 5, v0
v_xor_b32 v246, v246, v0
v_bfe_i32 v245, v246, 0, 1
v_mfma_f32_16x16x32_bf16 v[132:135], v[36:39], a[24:27], v[132:135]
ds_read_b128 a[32:35], v6 offset:4096
v_mfma_f32_16x16x32_bf16 v[116:119], v[36:39], a[20:23], v[116:119]
ds_read_b128 a[36:39], v6 offset:6144
buffer_load_dwordx4 v15, s[12:15], s57 offen offset:2080 lds
v_mfma_f32_16x16x32_bf16 v[100:103], v[36:39], a[16:19], v[100:103]
s_waitcnt lgkmcnt(8)
v_mfma_f32_16x16x32_bf16 v[104:107], v[40:43], a[16:19], v[104:107]
s_nop 0
ds_read_b64_tr_b16 v[36:37], v16 offset:16672
ds_read_b64_tr_b16 v[38:39], v16 offset:16928
v_mfma_f32_16x16x32_bf16 v[120:123], v[40:43], a[20:23], v[120:123]
s_add_u32 m0, s39, 12288
ds_read_b128 a[40:43], v8 offset:4096
ds_read_b128 a[44:47], v8 offset:6144
v_mfma_f32_16x16x32_bf16 v[136:139], v[40:43], a[24:27], v[136:139]
buffer_load_dwordx4 v2, s[4:7], s51 offen offset:0 lds
v_mfma_f32_16x16x32_bf16 v[152:155], v[40:43], a[28:31], v[152:155]
s_waitcnt lgkmcnt(10)
v_mfma_f32_16x16x32_bf16 v[156:159], v[44:47], a[28:31], v[156:159]
ds_read_b64_tr_b16 v[40:41], v16 offset:18720
v_mfma_f32_16x16x32_bf16 v[140:143], v[44:47], a[24:27], v[140:143]
ds_read_b64_tr_b16 v[42:43], v16 offset:18976
buffer_load_dwordx4 v3, s[4:7], s51 offen offset:1024 lds
v_mfma_f32_16x16x32_bf16 v[124:127], v[44:47], a[20:23], v[124:127]
v_mfma_f32_16x16x32_bf16 v[108:111], v[44:47], a[16:19], v[108:111]
s_waitcnt lgkmcnt(10)
buffer_load_dwordx4 v4, s[4:7], s51 offen offset:2048 lds
v_mfma_f32_16x16x32_bf16 v[80:83], a[16:19], v[248:251], v[80:83]
v_mfma_f32_16x16x32_bf16 v[84:87], a[20:23], v[248:251], v[84:87]
v_mfma_f32_16x16x32_bf16 v[88:91], a[16:19], v[252:255], v[88:91]
buffer_load_dwordx4 v5, s[4:7], s51 offen offset:3072 lds
v_mfma_f32_16x16x32_bf16 v[92:95], a[20:23], v[252:255], v[92:95]
s_waitcnt lgkmcnt(2)
v_mfma_f32_16x16x32_bf16 v[96:99], v[32:35], a[32:35], v[96:99]
s_nop 0
ds_read_b64_tr_b16 v[44:45], v16 offset:18752
ds_read_b64_tr_b16 v[46:47], v16 offset:19008
v_mfma_f32_16x16x32_bf16 v[112:115], v[32:35], a[36:39], v[112:115]
s_nop 0
ds_read_b128 a[48:51], v7 offset:4096
ds_read_b128 a[52:55], v7 offset:6144
v_mfma_f32_16x16x32_bf16 v[128:131], v[32:35], a[40:43], v[128:131]
s_add_u32 m0, s38, 49920
ds_read_b128 v[160:163], v24 offset:4096
ds_read_b128 v[164:167], v24 offset:5120
v_mfma_f32_16x16x32_bf16 v[144:147], v[32:35], a[44:47], v[144:147]
buffer_load_dwordx4 v14, s[8:11], s58 offen offset:0 lds
v_mfma_f32_16x16x32_bf16 v[148:151], v[36:39], a[44:47], v[148:151]
s_nop 0
ds_read_b64_tr_b16 v[32:33], v16 offset:24960
ds_read_b64_tr_b16 v[34:35], v16 offset:25216
v_mfma_f32_16x16x32_bf16 v[132:135], v[36:39], a[40:43], v[132:135]
ds_read_b128 a[56:59], v9 offset:4096
v_mfma_f32_16x16x32_bf16 v[116:119], v[36:39], a[36:39], v[116:119]
ds_read_b128 a[60:63], v9 offset:6144
buffer_load_dwordx4 v14, s[12:15], s58 offen offset:2080 lds
v_mfma_f32_16x16x32_bf16 v[100:103], v[36:39], a[32:35], v[100:103]
s_waitcnt lgkmcnt(10)
v_mfma_f32_16x16x32_bf16 v[104:107], v[40:43], a[32:35], v[104:107]
s_add_u32 m0, s38, 58240
ds_read_b64_tr_b16 v[36:37], v16 offset:24992
ds_read_b64_tr_b16 v[38:39], v16 offset:25248
v_mfma_f32_16x16x32_bf16 v[120:123], v[40:43], a[36:39], v[120:123]
buffer_load_dwordx4 v15, s[8:11], s58 offen offset:0 lds
v_mfma_f32_16x16x32_bf16 v[136:139], v[40:43], a[40:43], v[136:139]
v_mfma_f32_16x16x32_bf16 v[152:155], v[40:43], a[44:47], v[152:155]
s_waitcnt lgkmcnt(10)
buffer_load_dwordx4 v15, s[12:15], s58 offen offset:2080 lds
v_mfma_f32_16x16x32_bf16 v[156:159], v[44:47], a[44:47], v[156:159]
ds_read_b64_tr_b16 v[40:41], v16 offset:27040
v_mfma_f32_16x16x32_bf16 v[140:143], v[44:47], a[40:43], v[140:143]
s_add_u32 m0, s39, 0
ds_read_b64_tr_b16 v[42:43], v16 offset:27296
v_mfma_f32_16x16x32_bf16 v[124:127], v[44:47], a[36:39], v[124:127]
buffer_load_dwordx4 v2, s[4:7], s52 offen offset:0 lds
v_mfma_f32_16x16x32_bf16 v[108:111], v[44:47], a[32:35], v[108:111]
s_waitcnt lgkmcnt(8)
v_mfma_f32_16x16x32_bf16 v[80:83], a[32:35], v[160:163], v[80:83]
v_mfma_f32_16x16x32_bf16 v[84:87], a[36:39], v[160:163], v[84:87]
buffer_load_dwordx4 v3, s[4:7], s52 offen offset:1024 lds
v_mfma_f32_16x16x32_bf16 v[88:91], a[32:35], v[164:167], v[88:91]
v_mfma_f32_16x16x32_bf16 v[92:95], a[36:39], v[164:167], v[92:95]
s_waitcnt lgkmcnt(4)
v_mfma_f32_16x16x32_bf16 v[96:99], v[32:35], a[48:51], v[96:99]
s_nop 0
ds_read_b64_tr_b16 v[44:45], v16 offset:27072
ds_read_b64_tr_b16 v[46:47], v16 offset:27328
v_mfma_f32_16x16x32_bf16 v[112:115], v[32:35], a[52:55], v[112:115]
s_nop 0
ds_read_b128 v[248:251], v24 offset:6144
ds_read_b128 v[252:255], v24 offset:7168
v_mfma_f32_16x16x32_bf16 v[128:131], v[32:35], a[56:59], v[128:131]
buffer_load_dwordx4 v4, s[4:7], s52 offen offset:2048 lds
v_mfma_f32_16x16x32_bf16 v[144:147], v[32:35], a[60:63], v[144:147]
s_waitcnt vmcnt(11) lgkmcnt(6)
s_barrier
v_mfma_f32_16x16x32_bf16 v[148:151], v[36:39], a[60:63], v[148:151]
s_nop 0
ds_read_b64_tr_b16 v[32:33], v16 offset:33280
ds_read_b64_tr_b16 v[34:35], v16 offset:33536
v_mfma_f32_16x16x32_bf16 v[132:135], v[36:39], a[56:59], v[132:135]
ds_read_b128 a[64:67], v6 offset:8192
v_mfma_f32_16x16x32_bf16 v[116:119], v[36:39], a[52:55], v[116:119]
ds_read_b128 a[68:71], v6 offset:10240
buffer_load_dwordx4 v5, s[4:7], s52 offen offset:3072 lds
v_mfma_f32_16x16x32_bf16 v[100:103], v[36:39], a[48:51], v[100:103]
s_waitcnt lgkmcnt(8)
v_mfma_f32_16x16x32_bf16 v[104:107], v[40:43], a[48:51], v[104:107]
s_nop 0
ds_read_b64_tr_b16 v[36:37], v16 offset:33312
ds_read_b64_tr_b16 v[38:39], v16 offset:33568
v_mfma_f32_16x16x32_bf16 v[120:123], v[40:43], a[52:55], v[120:123]
s_add_u32 m0, s39, 4096
ds_read_b128 a[72:75], v8 offset:8192
ds_read_b128 a[76:79], v8 offset:10240
v_mfma_f32_16x16x32_bf16 v[136:139], v[40:43], a[56:59], v[136:139]
buffer_load_dwordx4 v2, s[4:7], s53 offen offset:0 lds
v_mfma_f32_16x16x32_bf16 v[152:155], v[40:43], a[60:63], v[152:155]
s_waitcnt lgkmcnt(10)
v_mfma_f32_16x16x32_bf16 v[156:159], v[44:47], a[60:63], v[156:159]
ds_read_b64_tr_b16 v[40:41], v16 offset:35360
v_mfma_f32_16x16x32_bf16 v[140:143], v[44:47], a[56:59], v[140:143]
ds_read_b64_tr_b16 v[42:43], v16 offset:35616
buffer_load_dwordx4 v3, s[4:7], s53 offen offset:1024 lds
v_mfma_f32_16x16x32_bf16 v[124:127], v[44:47], a[52:55], v[124:127]
v_mfma_f32_16x16x32_bf16 v[108:111], v[44:47], a[48:51], v[108:111]
s_waitcnt lgkmcnt(10)
buffer_load_dwordx4 v4, s[4:7], s53 offen offset:2048 lds
v_mfma_f32_16x16x32_bf16 v[80:83], a[48:51], v[248:251], v[80:83]
v_mfma_f32_16x16x32_bf16 v[84:87], a[52:55], v[248:251], v[84:87]
ds_read_b128 a[80:83], v7 offset:8192
v_mfma_f32_16x16x32_bf16 v[88:91], a[48:51], v[252:255], v[88:91]
ds_read_b128 a[84:87], v7 offset:10240
buffer_load_dwordx4 v5, s[4:7], s53 offen offset:3072 lds
v_mfma_f32_16x16x32_bf16 v[92:95], a[52:55], v[252:255], v[92:95]
s_waitcnt lgkmcnt(4)
v_mfma_f32_16x16x32_bf16 v[96:99], v[32:35], a[64:67], v[96:99]
s_nop 0
ds_read_b64_tr_b16 v[44:45], v16 offset:35392
ds_read_b64_tr_b16 v[46:47], v16 offset:35648
v_mfma_f32_16x16x32_bf16 v[112:115], v[32:35], a[68:71], v[112:115]
s_nop 0
ds_read_b128 a[88:91], v9 offset:8192
ds_read_b128 a[92:95], v9 offset:10240
v_mfma_f32_16x16x32_bf16 v[128:131], v[32:35], a[72:75], v[128:131]
s_add_u32 m0, s38, 66560
ds_read_b128 v[160:163], v24 offset:8192
ds_read_b128 v[164:167], v24 offset:9216
v_mfma_f32_16x16x32_bf16 v[144:147], v[32:35], a[76:79], v[144:147]
buffer_load_dwordx4 v14, s[8:11], s59 offen offset:0 lds
v_mfma_f32_16x16x32_bf16 v[148:151], v[36:39], a[76:79], v[148:151]
s_nop 0
ds_read_b64_tr_b16 v[32:33], v16 offset:41600
ds_read_b64_tr_b16 v[34:35], v16 offset:41856
v_mfma_f32_16x16x32_bf16 v[132:135], v[36:39], a[72:75], v[132:135]
ds_read_b128 v[248:251], v24 offset:10240
v_mfma_f32_16x16x32_bf16 v[116:119], v[36:39], a[68:71], v[116:119]
ds_read_b128 v[252:255], v24 offset:11264
buffer_load_dwordx4 v14, s[12:15], s59 offen offset:2080 lds
v_mfma_f32_16x16x32_bf16 v[100:103], v[36:39], a[64:67], v[100:103]
s_waitcnt lgkmcnt(12)
v_mfma_f32_16x16x32_bf16 v[104:107], v[40:43], a[64:67], v[104:107]
s_add_u32 m0, s38, 74880
ds_read_b64_tr_b16 v[36:37], v16 offset:41632
ds_read_b64_tr_b16 v[38:39], v16 offset:41888
v_mfma_f32_16x16x32_bf16 v[120:123], v[40:43], a[68:71], v[120:123]
buffer_load_dwordx4 v15, s[8:11], s59 offen offset:0 lds
v_mfma_f32_16x16x32_bf16 v[136:139], v[40:43], a[72:75], v[136:139]
v_lshrrev_b32 v193, 4, v0
v_and_b32 v192, 15, v0
v_lshl_add_u32 v194, s32, 4, v192
v_lshrrev_b32 v196, 2, v192
v_mfma_f32_16x16x32_bf16 v[152:155], v[40:43], a[76:79], v[152:155]
s_waitcnt lgkmcnt(10)
buffer_load_dwordx4 v15, s[12:15], s59 offen offset:2080 lds
v_and_b32 v197, 3, v192
v_lshl_add_u32 v195, v196, 3, v197
v_bfe_i32 v199, v0, 0, 1
v_mfma_f32_16x16x32_bf16 v[156:159], v[44:47], a[76:79], v[156:159]
ds_read_b64_tr_b16 v[40:41], v16 offset:43680
ds_read_b64_tr_b16 v[42:43], v16 offset:43936
v_and_b32 v199, 0x80008000, v199
v_cvt_f32_u32 v194, v194
v_mfma_f32_16x16x32_bf16 v[140:143], v[44:47], a[72:75], v[140:143]
s_add_u32 m0, s38, 0
s_waitcnt vmcnt(16)
ds_read_b128 a[96:99], v6 offset:12288
ds_read_b128 a[100:103], v6 offset:14336
v_cvt_f32_u32 v195, v195
v_mfma_f32_16x16x32_bf16 v[124:127], v[44:47], a[68:71], v[124:127]
buffer_load_dwordx4 v14, s[8:11], s60 offen offset:0 lds
v_cvt_f32_u32 v193, v193
v_mul_f32 v196, 0x3c800000, v194
v_mul_f32 v197, 4.0, v193
v_mfma_f32_16x16x32_bf16 v[108:111], v[44:47], a[64:67], v[108:111]
s_waitcnt lgkmcnt(6)
v_mul_f32 v197, v197, v196
v_cos_f32 v192, v196
v_add_f32 v209, v197, v196
v_mfma_f32_16x16x32_bf16 v[80:83], a[64:67], v[160:163], v[80:83]
v_add_f32 v192, v192, v192
v_cos_f32 v200, v197
v_mul_f32 v198, 0x3d800000, v197
v_mfma_f32_16x16x32_bf16 v[84:87], a[68:71], v[160:163], v[84:87]
ds_read_b128 a[112:115], v7 offset:12288
ds_read_b128 a[116:119], v7 offset:14336
v_sin_f32 v208, v197
v_mfma_f32_16x16x32_bf16 v[88:91], a[64:67], v[164:167], v[88:91]
buffer_load_dwordx4 v14, s[12:15], s60 offen offset:2080 lds
v_cos_f32 v201, v209
v_fmamk_f32 v197, v196, 0x41800000, v197
v_mfma_f32_16x16x32_bf16 v[92:95], a[68:71], v[164:167], v[92:95]
v_sin_f32 v209, v209
v_cos_f32 v204, v197
v_mfma_f32_16x16x32_bf16 v[80:83], a[80:83], v[248:251], v[80:83]
s_add_u32 m0, s38, 8320
buffer_store_dwordx4 v[232:235], v1, s[20:23], s74 offen offset:0 sc1
v_fma_f32 v202, v192, v201, -v200
v_sin_f32 v212, v197
v_mfma_f32_16x16x32_bf16 v[84:87], a[84:87], v[248:251], v[84:87]
buffer_load_dwordx4 v15, s[8:11], s60 offen offset:0 lds
v_fma_f32 v210, v192, v209, -v208
v_fma_f32 v203, v192, v202, -v201
v_fma_f32 v211, v192, v210, -v209
v_mfma_f32_16x16x32_bf16 v[88:91], a[80:83], v[252:255], v[88:91]
v_add_f32 v213, v197, v196
v_cos_f32 v205, v213
v_cvt_pk_bf16_f32 v216, v200, v201
v_mfma_f32_16x16x32_bf16 v[92:95], a[84:87], v[252:255], v[92:95]
v_sin_f32 v213, v213
v_fma_f32 v206, v192, v205, -v204
v_fma_f32 v214, v192, v213, -v212
v_mfma_f32_16x16x32_bf16 v[96:99], v[32:35], a[80:83], v[96:99]
ds_read_b64_tr_b16 v[44:45], v16 offset:43712
ds_read_b64_tr_b16 v[46:47], v16 offset:43968
v_fma_f32 v207, v192, v206, -v205
v_fma_f32 v215, v192, v214, -v213
v_mfma_f32_16x16x32_bf16 v[112:115], v[32:35], a[84:87], v[112:115]
ds_read_b128 v[160:163], v24 offset:12288
ds_read_b128 v[164:167], v24 offset:13312
v_cvt_pk_bf16_f32 v217, v202, v203
v_cvt_pk_bf16_f32 v218, v204, v205
v_mfma_f32_16x16x32_bf16 v[128:131], v[32:35], a[88:91], v[128:131]
buffer_store_dwordx4 v[232:235], v1, s[20:23], s74 offen offset:1024 sc1
v_cvt_pk_bf16_f32 v219, v206, v207
v_cvt_pk_bf16_f32 v220, v208, v209
v_cvt_pk_bf16_f32 v221, v210, v211
v_mfma_f32_16x16x32_bf16 v[144:147], v[32:35], a[92:95], v[144:147]
s_waitcnt vmcnt(17) lgkmcnt(10)
s_barrier
v_mfma_f32_16x16x32_bf16 v[148:151], v[36:39], a[92:95], v[148:151]
ds_read_b64_tr_b16 v[32:33], v16 offset:49920
ds_read_b64_tr_b16 v[34:35], v16 offset:50176
v_cvt_pk_bf16_f32 v222, v212, v213
v_cvt_pk_bf16_f32 v223, v214, v215
v_mfma_f32_16x16x32_bf16 v[132:135], v[36:39], a[88:91], v[132:135]
ds_read_b128 a[104:107], v8 offset:12288
ds_read_b128 a[108:111], v8 offset:14336
v_accvgpr_write_b32 a224, v216
v_accvgpr_write_b32 a225, v217
v_mfma_f32_16x16x32_bf16 v[116:119], v[36:39], a[84:87], v[116:119]
s_add_u32 m0, s39, 8192
ds_read_b128 v[248:251], v24 offset:0
s_waitcnt lgkmcnt(10)
ds_read_b128 v[252:255], v24 offset:1024
v_accvgpr_write_b32 a226, v218
v_accvgpr_write_b32 a227, v219
v_mfma_f32_16x16x32_bf16 v[100:103], v[36:39], a[80:83], v[100:103]
buffer_load_dwordx4 v2, s[4:7], s54 offen offset:0 lds
v_accvgpr_write_b32 a232, v220
v_accvgpr_write_b32 a233, v221
v_accvgpr_write_b32 a234, v222
v_mfma_f32_16x16x32_bf16 v[104:107], v[40:43], a[80:83], v[104:107]
ds_read_b64_tr_b16 v[36:37], v16 offset:49952
ds_read_b64_tr_b16 v[38:39], v16 offset:50208
v_accvgpr_write_b32 a235, v223
v_xor_b32 v216, v199, v216
v_mfma_f32_16x16x32_bf16 v[120:123], v[40:43], a[84:87], v[120:123]
v_xor_b32 v217, v199, v217
v_xor_b32 v218, v199, v218
v_xor_b32 v219, v199, v219
v_xor_b32 v220, v199, v220
v_mfma_f32_16x16x32_bf16 v[136:139], v[40:43], a[88:91], v[136:139]
buffer_load_dwordx4 v3, s[4:7], s54 offen offset:1024 lds
v_xor_b32 v221, v199, v221
v_xor_b32 v222, v199, v222
v_xor_b32 v223, v199, v223
v_mfma_f32_16x16x32_bf16 v[152:155], v[40:43], a[92:95], v[152:155]
s_waitcnt lgkmcnt(10)
v_accvgpr_write_b32 a228, v216
v_accvgpr_write_b32 a229, v217
v_accvgpr_write_b32 a230, v218
v_accvgpr_write_b32 a231, v219
v_mfma_f32_16x16x32_bf16 v[156:159], v[44:47], a[92:95], v[156:159]
ds_read_b64_tr_b16 v[40:41], v16 offset:52000
ds_read_b64_tr_b16 v[42:43], v16 offset:52256
v_accvgpr_write_b32 a236, v220
v_accvgpr_write_b32 a237, v221
v_mfma_f32_16x16x32_bf16 v[140:143], v[44:47], a[88:91], v[140:143]
s_waitcnt vmcnt(15)
ds_read_b128 a[128:131], v6 offset:0
ds_read_b128 a[132:135], v6 offset:2048
v_accvgpr_write_b32 a238, v222
v_mfma_f32_16x16x32_bf16 v[124:127], v[44:47], a[84:87], v[124:127]
v_accvgpr_write_b32 a239, v223
v_xor_b32 v220, 0x80008000, v220
v_xor_b32 v221, 0x80008000, v221
v_xor_b32 v222, 0x80008000, v222
v_mfma_f32_16x16x32_bf16 v[108:111], v[44:47], a[80:83], v[108:111]
s_waitcnt lgkmcnt(6)
v_xor_b32 v223, 0x80008000, v223
v_accvgpr_write_b32 a244, v220
v_accvgpr_write_b32 a245, v221
v_accvgpr_write_b32 a246, v222
v_mfma_f32_16x16x32_bf16 v[80:83], a[96:99], v[160:163], v[80:83]
buffer_load_dwordx4 v4, s[4:7], s54 offen offset:2048 lds
v_accvgpr_write_b32 a247, v223
v_xor_b32 v220, v199, v220
v_xor_b32 v221, v199, v221
v_mfma_f32_16x16x32_bf16 v[84:87], a[100:103], v[160:163], v[84:87]
ds_read_b128 a[144:147], v7 offset:0
ds_read_b128 a[148:151], v7 offset:2048
v_xor_b32 v222, v199, v222
v_xor_b32 v223, v199, v223
v_mfma_f32_16x16x32_bf16 v[88:91], a[96:99], v[164:167], v[88:91]
v_accvgpr_write_b32 a240, v220
v_accvgpr_write_b32 a241, v221
v_accvgpr_write_b32 a242, v222
v_accvgpr_write_b32 a243, v223
v_mfma_f32_16x16x32_bf16 v[92:95], a[100:103], v[164:167], v[92:95]
v_mul_f32 v196, 0x3d000000, v196
v_mov_b32 v197, v198
v_cos_f32 v192, v196
v_mfma_f32_16x16x32_bf16 v[176:179], a[112:115], v[248:251], 0
v_add_f32 v192, v192, v192
v_add_f32 v57, v197, v196
v_cos_f32 v48, v197
v_mfma_f32_16x16x32_bf16 v[180:183], a[116:119], v[248:251], 0
buffer_load_dwordx4 v5, s[4:7], s54 offen offset:3072 lds
v_sin_f32 v56, v197
v_mfma_f32_16x16x32_bf16 v[184:187], a[112:115], v[252:255], 0
v_cos_f32 v49, v57
v_sin_f32 v57, v57
v_mfma_f32_16x16x32_bf16 v[188:191], a[116:119], v[252:255], 0
v_fma_f32 v50, v192, v49, -v48
v_fma_f32 v58, v192, v57, -v56
v_fma_f32 v51, v192, v50, -v49
v_fma_f32 v59, v192, v58, -v57
v_mfma_f32_16x16x32_bf16 v[96:99], v[32:35], a[96:99], v[96:99]
ds_read_b64_tr_b16 v[44:45], v16 offset:52032
ds_read_b64_tr_b16 v[46:47], v16 offset:52288
v_fma_f32 v52, v192, v51, -v50
v_fma_f32 v60, v192, v59, -v58
v_mfma_f32_16x16x32_bf16 v[112:115], v[32:35], a[100:103], v[112:115]
L_pad0:
s_cbranch_execz L_pad4
ds_read_b128 a[120:123], v9 offset:12288
ds_read_b128 a[124:127], v9 offset:14336
v_fma_f32 v53, v192, v52, -v51
v_fma_f32 v61, v192, v60, -v59
v_mfma_f32_16x16x32_bf16 v[128:131], v[32:35], a[104:107], v[128:131]
s_add_u32 m0, s38, 8320
ds_read_b128 v[160:163], v24 offset:2048
ds_read_b128 v[164:167], v24 offset:3072
v_fma_f32 v54, v192, v53, -v52
v_fma_f32 v62, v192, v61, -v60
v_mfma_f32_16x16x32_bf16 v[144:147], v[32:35], a[108:111], v[144:147]
s_waitcnt lgkmcnt(12)
buffer_load_dwordx4 v15, s[12:15], s60 offen offset:2080 lds
v_fma_f32 v55, v192, v54, -v53
v_fma_f32 v63, v192, v62, -v61
v_cvt_f32_u32 v198, s32
v_mfma_f32_16x16x32_bf16 v[148:151], v[36:39], a[108:111], v[148:151]
ds_read_b64_tr_b16 v[32:33], v16 offset:58240
ds_read_b64_tr_b16 v[34:35], v16 offset:58496
v_fma_f32 v198, v198, 4.0, v193
v_mul_f32 v198, 4.0, v198
v_mfma_f32_16x16x32_bf16 v[132:135], v[36:39], a[104:107], v[132:135]
ds_read_b128 v[248:251], v24 offset:4096
s_waitcnt lgkmcnt(10)
ds_read_b128 v[252:255], v24 offset:5120
v_mul_f32 v193, 0x41000000, v193
v_mul_f32 v196, 0x3d000000, v195
v_mfma_f32_16x16x32_bf16 v[116:119], v[36:39], a[100:103], v[116:119]
v_mul_f32 v197, v193, v196
v_cos_f32 v192, v196
v_add_f32 v209, v197, v196
v_mfma_f32_16x16x32_bf16 v[100:103], v[36:39], a[96:99], v[100:103]
v_add_f32 v192, v192, v192
v_cos_f32 v200, v197
v_mul_f32 v196, 0x3c800000, v196
v_mfma_f32_16x16x32_bf16 v[104:107], v[40:43], a[96:99], v[104:107]
s_add_u32 m0, s38, 16640
ds_read_b64_tr_b16 v[36:37], v16 offset:58272
ds_read_b64_tr_b16 v[38:39], v16 offset:58528
v_sin_f32 v208, v197
v_mfma_f32_16x16x32_bf16 v[120:123], v[40:43], a[100:103], v[120:123]
buffer_load_dwordx4 v14, s[8:11], s61 offen offset:0 lds
v_cos_f32 v201, v209
v_mul_f32 v197, v198, v196
v_mfma_f32_16x16x32_bf16 v[136:139], v[40:43], a[104:107], v[136:139]
v_sin_f32 v209, v209
v_cos_f32 v64, v197
v_mfma_f32_16x16x32_bf16 v[152:155], v[40:43], a[108:111], v[152:155]
s_waitcnt lgkmcnt(10)
v_fma_f32 v202, v192, v201, -v200
v_fma_f32 v210, v192, v209, -v208
v_sin_f32 v72, v197
v_mfma_f32_16x16x32_bf16 v[156:159], v[44:47], a[108:111], v[156:159]
ds_read_b64_tr_b16 v[40:41], v16 offset:60320
ds_read_b64_tr_b16 v[42:43], v16 offset:60576
v_fma_f32 v203, v192, v202, -v201
v_fma_f32 v211, v192, v210, -v209
v_mfma_f32_16x16x32_bf16 v[140:143], v[44:47], a[104:107], v[140:143]
s_waitcnt vmcnt(15)
ds_read_b128 a[160:163], v6 offset:4096
ds_read_b128 a[164:167], v6 offset:6144
v_fma_f32 v204, v192, v203, -v202
v_mfma_f32_16x16x32_bf16 v[124:127], v[44:47], a[100:103], v[124:127]
buffer_load_dwordx4 v14, s[12:15], s61 offen offset:2080 lds
v_fma_f32 v212, v192, v211, -v210
v_fma_f32 v205, v192, v204, -v203
v_fma_f32 v213, v192, v212, -v211
v_mfma_f32_16x16x32_bf16 v[108:111], v[44:47], a[96:99], v[108:111]
s_waitcnt lgkmcnt(6)
v_fma_f32 v206, v192, v205, -v204
v_fma_f32 v214, v192, v213, -v212
v_fma_f32 v207, v192, v206, -v205
v_fma_f32 v215, v192, v214, -v213
v_mfma_f32_16x16x32_bf16 v[176:179], a[128:131], v[160:163], v[176:179]
v_cvt_pk_bf16_f32 v216, v200, v201
v_cvt_pk_bf16_f32 v217, v202, v203
v_cos_f32 v192, v196
v_mfma_f32_16x16x32_bf16 v[180:183], a[132:135], v[160:163], v[180:183]
ds_read_b128 a[176:179], v7 offset:4096
ds_read_b128 a[180:183], v7 offset:6144
v_cvt_pk_bf16_f32 v218, v204, v205
v_cvt_pk_bf16_f32 v219, v206, v207
v_mfma_f32_16x16x32_bf16 v[184:187], a[128:131], v[164:167], v[184:187]
s_add_u32 m0, s38, 24960
v_cvt_pk_bf16_f32 v224, v208, v209
v_cvt_pk_bf16_f32 v225, v210, v211
v_cvt_pk_bf16_f32 v226, v212, v213
v_cvt_pk_bf16_f32 v227, v214, v215
v_mfma_f32_16x16x32_bf16 v[188:191], a[132:135], v[164:167], v[188:191]
buffer_load_dwordx4 v15, s[8:11], s61 offen offset:0 lds
v_accvgpr_write_b32 a248, v216
v_accvgpr_write_b32 a249, v217
v_accvgpr_write_b32 a250, v218
v_mfma_f32_16x16x32_bf16 v[176:179], a[144:147], v[248:251], v[176:179]
v_accvgpr_write_b32 a251, v219
v_add_f32 v192, v192, v192
v_add_f32 v73, v197, v196
v_mul_f32 v64, s71, v64
v_mfma_f32_16x16x32_bf16 v[180:183], a[148:151], v[248:251], v[180:183]
v_cos_f32 v65, v73
v_sin_f32 v73, v73
v_mfma_f32_16x16x32_bf16 v[184:187], a[144:147], v[252:255], v[184:187]
v_mul_f32 v72, s71, v72
v_mul_f32 v65, s71, v65
v_mul_f32 v73, s71, v73
v_fma_f32 v66, v192, v65, -v64
v_mfma_f32_16x16x32_bf16 v[188:191], a[148:151], v[252:255], v[188:191]
v_fma_f32 v74, v192, v73, -v72
v_fma_f32 v67, v192, v66, -v65
v_fma_f32 v75, v192, v74, -v73
v_add_f32 v195, 4.0, v195
v_mfma_f32_16x16x32_bf16 v[96:99], v[32:35], a[112:115], v[96:99]
ds_read_b64_tr_b16 v[44:45], v16 offset:60352
ds_read_b64_tr_b16 v[46:47], v16 offset:60608
v_mul_f32 v196, 0x3d000000, v195
v_mul_f32 v197, v193, v196
v_mfma_f32_16x16x32_bf16 v[112:115], v[32:35], a[116:119], v[112:115]
ds_read_b128 v[160:163], v24 offset:6144
ds_read_b128 v[164:167], v24 offset:7168
v_cos_f32 v192, v196
v_mfma_f32_16x16x32_bf16 v[128:131], v[32:35], a[120:123], v[128:131]
buffer_load_dwordx4 v15, s[12:15], s61 offen offset:2080 lds
v_mfma_f32_16x16x32_bf16 v[144:147], v[32:35], a[124:127], v[144:147]
s_waitcnt vmcnt(14) lgkmcnt(10)
s_barrier
v_mfma_f32_16x16x32_bf16 v[148:151], v[36:39], a[124:127], v[148:151]
s_nop 0
ds_read_b64_tr_b16 v[32:33], v17 offset:0
ds_read_b64_tr_b16 v[34:35], v17 offset:256
v_mfma_f32_16x16x32_bf16 v[132:135], v[36:39], a[120:123], v[132:135]
s_addk_i32 s55, 128
ds_read_b128 a[136:139], v8 offset:0
ds_read_b128 a[140:143], v8 offset:2048
v_cos_f32 v200, v197
v_mfma_f32_16x16x32_bf16 v[116:119], v[36:39], a[116:119], v[116:119]
s_add_u32 m0, s38, 33280
ds_read_b128 v[248:251], v24 offset:8192
s_waitcnt lgkmcnt(10)
ds_read_b128 v[252:255], v24 offset:9216
v_sin_f32 v208, v197
v_mfma_f32_16x16x32_bf16 v[100:103], v[36:39], a[112:115], v[100:103]
buffer_load_dwordx4 v14, s[8:11], s55 offen offset:0 lds
v_add_f32 v192, v192, v192
v_add_f32 v209, v197, v196
v_mul_f32 v196, 0x3c800000, v196
v_mfma_f32_16x16x32_bf16 v[104:107], v[40:43], a[112:115], v[104:107]
ds_read_b64_tr_b16 v[36:37], v17 offset:32
ds_read_b64_tr_b16 v[38:39], v17 offset:288
v_cos_f32 v201, v209
v_mfma_f32_16x16x32_bf16 v[120:123], v[40:43], a[116:119], v[120:123]
v_sin_f32 v209, v209
v_fma_f32 v202, v192, v201, -v200
v_fma_f32 v210, v192, v209, -v208
v_mfma_f32_16x16x32_bf16 v[136:139], v[40:43], a[120:123], v[136:139]
v_fma_f32 v203, v192, v202, -v201
v_fma_f32 v211, v192, v210, -v209
v_fma_f32 v204, v192, v203, -v202
v_fma_f32 v212, v192, v211, -v210
v_mfma_f32_16x16x32_bf16 v[152:155], v[40:43], a[124:127], v[152:155]
s_waitcnt lgkmcnt(10)
v_fma_f32 v205, v192, v204, -v203
v_fma_f32 v213, v192, v212, -v211
v_fma_f32 v206, v192, v205, -v204
v_fma_f32 v214, v192, v213, -v212
v_mfma_f32_16x16x32_bf16 v[156:159], v[44:47], a[124:127], v[156:159]
ds_read_b64_tr_b16 v[40:41], v17 offset:2080
ds_read_b64_tr_b16 v[42:43], v17 offset:2336
v_fma_f32 v207, v192, v206, -v205
v_fma_f32 v215, v192, v214, -v213
v_mfma_f32_16x16x32_bf16 v[140:143], v[44:47], a[120:123], v[140:143]
s_waitcnt vmcnt(6)
ds_read_b128 a[192:195], v6 offset:8192
v_mfma_f32_16x16x32_bf16 v[124:127], v[44:47], a[116:119], v[124:127]
s_lshl_b32 s41, s37, 13
ds_read_b128 a[196:199], v6 offset:10240
buffer_load_dwordx4 v14, s[12:15], s55 offen offset:2080 lds
v_mfma_f32_16x16x32_bf16 v[108:111], v[44:47], a[112:115], v[108:111]
s_waitcnt lgkmcnt(6)
v_mfma_f32_16x16x32_bf16 v[176:179], a[160:163], v[160:163], v[176:179]
s_lshl_b32 s40, s32, 10
v_mfma_f32_16x16x32_bf16 v[180:183], a[164:167], v[160:163], v[180:183]
s_add_u32 m0, s38, 41600
ds_read_b128 a[208:211], v7 offset:8192
ds_read_b128 a[212:215], v7 offset:10240
v_mfma_f32_16x16x32_bf16 v[184:187], a[160:163], v[164:167], v[184:187]
s_add_u32 s42, s41, s40
buffer_load_dwordx4 v15, s[8:11], s55 offen offset:0 lds
v_mfma_f32_16x16x32_bf16 v[188:191], a[164:167], v[164:167], v[188:191]
s_cmp_eq_u32 s37, 224
s_cselect_b32 s48, 4096, s41
s_cselect_b32 s41, 0, s41
s_cselect_b32 s49, 16, 0
v_mfma_f32_16x16x32_bf16 v[176:179], a[176:179], v[248:251], v[176:179]
s_cmp_eq_u32 s41, 0
s_cselect_b32 s43, 1073741824, 0
v_xor_b32 v244, s49, v1
v_mfma_f32_16x16x32_bf16 v[180:183], a[180:183], v[248:251], v[180:183]
s_add_u32 s48, s48, s40
v_and_or_b32 v245, v245, s43, v244
v_or_b32 v244, s43, v1
v_mfma_f32_16x16x32_bf16 v[184:187], a[176:179], v[252:255], v[184:187]
s_lshl_b32 s40, s40, 1
v_add_u32 v244, 0x1000, v244
v_mfma_f32_16x16x32_bf16 v[188:191], a[180:183], v[252:255], v[188:191]
buffer_load_dwordx4 v15, s[12:15], s55 offen offset:2080 lds
v_mfma_f32_16x16x32_bf16 v[96:99], v[32:35], a[128:131], v[96:99]
s_add_u32 s41, s41, s40
ds_read_b64_tr_b16 v[44:45], v17 offset:2112
ds_read_b64_tr_b16 v[46:47], v17 offset:2368
v_mfma_f32_16x16x32_bf16 v[112:115], v[32:35], a[132:135], v[112:115]
s_add_u32 s41, s41, 1048576
ds_read_b128 a[152:155], v9 offset:0
ds_read_b128 a[156:159], v9 offset:2048
v_mfma_f32_16x16x32_bf16 v[128:131], v[32:35], a[136:139], v[128:131]
s_add_u32 s42, s42, 4718592
ds_read_b128 v[160:163], v24 offset:10240
ds_read_b128 v[164:167], v24 offset:11264
v_mfma_f32_16x16x32_bf16 v[144:147], v[32:35], a[140:143], v[144:147]
s_waitcnt lgkmcnt(12)
v_mfma_f32_16x16x32_bf16 v[148:151], v[36:39], a[140:143], v[148:151]
s_add_u32 s48, s48, 2883584
ds_read_b64_tr_b16 v[32:33], v17 offset:8320
ds_read_b64_tr_b16 v[34:35], v17 offset:8576
v_mfma_f32_16x16x32_bf16 v[132:135], v[36:39], a[136:139], v[132:135]
s_add_u32 m0, s39, 12288
ds_read_b128 v[248:251], v24 offset:12288
s_waitcnt lgkmcnt(10)
ds_read_b128 v[252:255], v24 offset:13312
v_mfma_f32_16x16x32_bf16 v[116:119], v[36:39], a[132:135], v[116:119]
s_and_b32 s47, s32, 1
buffer_load_dwordx4 v18, s[16:19], s62 offen offset:0 lds
v_and_b32 v4, 7, v0
v_mfma_f32_16x16x32_bf16 v[100:103], v[36:39], a[128:131], v[100:103]
v_min_u32 v4, 6, v4
v_bfe_u32 v5, v0, 3, 1
v_mfma_f32_16x16x32_bf16 v[104:107], v[40:43], a[128:131], v[104:107]
s_mul_i32 s47, s47, 28
ds_read_b64_tr_b16 v[36:37], v17 offset:8352
ds_read_b64_tr_b16 v[38:39], v17 offset:8608
v_mfma_f32_16x16x32_bf16 v[120:123], v[40:43], a[132:135], v[120:123]
s_add_u32 s47, s47, s72
v_lshl_add_u32 v4, v5, 7, v4
v_lshlrev_b32 v4, 2, v4
v_mfma_f32_16x16x32_bf16 v[136:139], v[40:43], a[136:139], v[136:139]
s_and_b32 s50, s72, 2
buffer_load_dwordx4 v19, s[16:19], s62 offen offset:1024 lds
v_mfma_f32_16x16x32_bf16 v[152:155], v[40:43], a[140:143], v[152:155]
s_waitcnt lgkmcnt(10)
v_mfma_f32_16x16x32_bf16 v[156:159], v[44:47], a[140:143], v[156:159]
s_mul_i32 s50, s50, 6
ds_read_b64_tr_b16 v[40:41], v17 offset:10400
ds_read_b64_tr_b16 v[42:43], v17 offset:10656
v_mfma_f32_16x16x32_bf16 v[140:143], v[44:47], a[136:139], v[140:143]
s_add_u32 s47, s47, s50
v_mfma_f32_16x16x32_bf16 v[124:127], v[44:47], a[132:135], v[124:127]
s_lshl_b32 s47, s47, 11
buffer_load_dword v28, v30, s[28:31], 0 offen sc1
v_mfma_f32_16x16x32_bf16 v[108:111], v[44:47], a[128:131], v[108:111]
s_waitcnt lgkmcnt(4)
buffer_load_dwordx4 v20, s[16:19], s62 offen offset:2048 lds
v_mfma_f32_16x16x32_bf16 v[176:179], a[192:195], v[160:163], v[176:179]
s_add_u32 s47, s47, 6561792
v_add_u32 v2, s47, v1
v_mfma_f32_16x16x32_bf16 v[180:183], a[196:199], v[160:163], v[180:183]
s_mul_i32 s50, s35, 229376
v_add_u32 v3, s50, v2
v_mfma_f32_16x16x32_bf16 v[184:187], a[192:195], v[164:167], v[184:187]
s_xor_b32 s47, s35, 1
v_mfma_f32_16x16x32_bf16 v[188:191], a[196:199], v[164:167], v[188:191]
s_mul_i32 s50, s47, 229376
v_add_u32 v2, s50, v2
v_mfma_f32_16x16x32_bf16 v[176:179], a[208:211], v[248:251], v[176:179]
s_lshl3_add_u32 s50, s33, s72
v_mfma_f32_16x16x32_bf16 v[180:183], a[212:215], v[248:251], v[180:183]
s_lshl_b32 s50, s50, 7
buffer_load_dwordx4 v21, s[16:19], s62 offen offset:3072 lds
v_mfma_f32_16x16x32_bf16 v[184:187], a[208:211], v[252:255], v[184:187]
s_add_u32 s50, s50, 131072
v_mfma_f32_16x16x32_bf16 v[188:191], a[212:215], v[252:255], v[188:191]
v_mfma_f32_16x16x32_bf16 v[96:99], v[32:35], a[144:147], v[96:99]
ds_read_b64_tr_b16 v[44:45], v17 offset:10432
v_mfma_f32_16x16x32_bf16 v[112:115], v[32:35], a[148:151], v[112:115]
ds_read_b64_tr_b16 v[46:47], v17 offset:10688
v_mfma_f32_16x16x32_bf16 v[128:131], v[32:35], a[152:155], v[128:131]
v_mfma_f32_16x16x32_bf16 v[144:147], v[32:35], a[156:159], v[144:147]
s_waitcnt vmcnt(13) lgkmcnt(4)
s_barrier
v_mfma_f32_16x16x32_bf16 v[148:151], v[36:39], a[156:159], v[148:151]
s_nop 0
ds_read_b64_tr_b16 v[32:33], v16 offset:0
ds_read_b64_tr_b16 v[34:35], v16 offset:256
v_mfma_f32_16x16x32_bf16 v[132:135], v[36:39], a[152:155], v[132:135]
s_add_u32 m0, s38, 49920
ds_read_b128 a[168:171], v8 offset:4096
ds_read_b128 a[172:175], v8 offset:6144
v_mfma_f32_16x16x32_bf16 v[116:119], v[36:39], a[148:151], v[116:119]
s_addk_i32 s56, 128
buffer_load_dwordx4 v14, s[8:11], s56 offen offset:0 lds
s_mov_b32 vcc_lo, 0x33333333
v_mfma_f32_16x16x32_bf16 v[100:103], v[36:39], a[144:147], v[100:103]
s_waitcnt lgkmcnt(6)
s_mov_b32 vcc_hi, 0x33333333
v_fmac_f32 v176, v25, v80
v_mfma_f32_16x16x32_bf16 v[104:107], v[40:43], a[144:147], v[104:107]
s_nop 0
ds_read_b64_tr_b16 v[36:37], v16 offset:32
ds_read_b64_tr_b16 v[38:39], v16 offset:288
v_mfma_f32_16x16x32_bf16 v[120:123], v[40:43], a[148:151], v[120:123]
buffer_load_dwordx4 v14, s[12:15], s56 offen offset:2080 lds
v_fmac_f32 v177, v25, v81
v_mfma_f32_16x16x32_bf16 v[136:139], v[40:43], a[152:155], v[136:139]
v_fmac_f32 v178, v25, v82
v_fmac_f32 v179, v25, v83
v_mfma_f32_16x16x32_bf16 v[152:155], v[40:43], a[156:159], v[152:155]
s_waitcnt lgkmcnt(6)
v_fmac_f32 v180, v25, v84
v_fmac_f32 v181, v25, v85
v_mfma_f32_16x16x32_bf16 v[156:159], v[44:47], a[156:159], v[156:159]
s_nop 0
ds_read_b64_tr_b16 v[40:41], v16 offset:2080
ds_read_b64_tr_b16 v[42:43], v16 offset:2336
v_mfma_f32_16x16x32_bf16 v[140:143], v[44:47], a[152:155], v[140:143]
v_fmac_f32 v182, v25, v86
v_fmac_f32 v183, v25, v87
v_mfma_f32_16x16x32_bf16 v[124:127], v[44:47], a[148:151], v[124:127]
s_add_u32 m0, s38, 58240
v_fmac_f32 v184, v25, v88
v_fmac_f32 v185, v25, v89
v_mfma_f32_16x16x32_bf16 v[108:111], v[44:47], a[144:147], v[108:111]
s_waitcnt lgkmcnt(4)
buffer_load_dwordx4 v15, s[8:11], s56 offen offset:0 lds
v_fmac_f32 v186, v25, v90
v_mfma_f32_16x16x32_bf16 v[96:99], v[32:35], a[160:163], v[96:99]
s_nop 0
ds_read_b64_tr_b16 v[44:45], v16 offset:2112
ds_read_b64_tr_b16 v[46:47], v16 offset:2368
v_mfma_f32_16x16x32_bf16 v[112:115], v[32:35], a[164:167], v[112:115]
s_nop 0
ds_read_b128 a[184:187], v9 offset:4096
ds_read_b128 a[188:191], v9 offset:6144
v_mfma_f32_16x16x32_bf16 v[128:131], v[32:35], a[168:171], v[128:131]
v_fmac_f32 v187, v25, v91
v_fmac_f32 v188, v25, v92
v_mfma_f32_16x16x32_bf16 v[144:147], v[32:35], a[172:175], v[144:147]
s_waitcnt lgkmcnt(6)
v_fmac_f32 v189, v25, v93
v_fmac_f32 v190, v25, v94
v_mfma_f32_16x16x32_bf16 v[148:151], v[36:39], a[172:175], v[148:151]
s_nop 0
ds_read_b64_tr_b16 v[32:33], v16 offset:8320
ds_read_b64_tr_b16 v[34:35], v16 offset:8576
v_mfma_f32_16x16x32_bf16 v[132:135], v[36:39], a[168:171], v[132:135]
buffer_load_dwordx4 v15, s[12:15], s56 offen offset:2080 lds
v_fmac_f32 v191, v25, v95
v_mfma_f32_16x16x32_bf16 v[116:119], v[36:39], a[164:167], v[116:119]
v_cvt_pk_bf16_f32 v80, v176, v177
v_cvt_pk_bf16_f32 v81, v178, v179
v_mfma_f32_16x16x32_bf16 v[100:103], v[36:39], a[160:163], v[100:103]
s_waitcnt lgkmcnt(6)
v_cvt_pk_bf16_f32 v82, v180, v181
v_cvt_pk_bf16_f32 v83, v182, v183
v_mfma_f32_16x16x32_bf16 v[104:107], v[40:43], a[160:163], v[104:107]
s_nop 0
ds_read_b64_tr_b16 v[36:37], v16 offset:8352
ds_read_b64_tr_b16 v[38:39], v16 offset:8608
v_mfma_f32_16x16x32_bf16 v[120:123], v[40:43], a[164:167], v[120:123]
v_cvt_pk_bf16_f32 v84, v184, v185
v_cvt_pk_bf16_f32 v85, v186, v187
v_mfma_f32_16x16x32_bf16 v[136:139], v[40:43], a[168:171], v[136:139]
v_cvt_pk_bf16_f32 v86, v188, v189
v_cvt_pk_bf16_f32 v87, v190, v191
v_mfma_f32_16x16x32_bf16 v[152:155], v[40:43], a[172:175], v[152:155]
s_waitcnt lgkmcnt(6)
v_permlane16_swap_b32 v80, v84
v_permlane16_swap_b32 v81, v85
v_mfma_f32_16x16x32_bf16 v[156:159], v[44:47], a[172:175], v[156:159]
s_nop 0
ds_read_b64_tr_b16 v[40:41], v16 offset:10400
ds_read_b64_tr_b16 v[42:43], v16 offset:10656
v_mfma_f32_16x16x32_bf16 v[140:143], v[44:47], a[168:171], v[140:143]
v_permlane16_swap_b32 v82, v86
v_permlane16_swap_b32 v83, v87
v_mfma_f32_16x16x32_bf16 v[124:127], v[44:47], a[164:167], v[124:127]
v_cndmask_b32_dpp v88, v84, v80, vcc quad_perm:[2,3,0,1] row_mask:0xf bank_mask:0xf
v_cndmask_b32_dpp v89, v85, v81, vcc quad_perm:[2,3,0,1] row_mask:0xf bank_mask:0xf
v_mfma_f32_16x16x32_bf16 v[108:111], v[44:47], a[160:163], v[108:111]
s_waitcnt lgkmcnt(4)
v_cndmask_b32_dpp v90, v86, v82, vcc quad_perm:[2,3,0,1] row_mask:0xf bank_mask:0xf
v_cndmask_b32_dpp v91, v87, v83, vcc quad_perm:[2,3,0,1] row_mask:0xf bank_mask:0xf
v_mfma_f32_16x16x32_bf16 v[96:99], v[32:35], a[176:179], v[96:99]
s_not_b64 vcc, vcc
ds_read_b64_tr_b16 v[44:45], v16 offset:10432
ds_read_b64_tr_b16 v[46:47], v16 offset:10688
v_mfma_f32_16x16x32_bf16 v[112:115], v[32:35], a[180:183], v[112:115]
buffer_store_dwordx4 v[88:91], v26, s[20:23], 0 offen sc1
v_cndmask_b32_dpp v92, v80, v84, vcc quad_perm:[2,3,0,1] row_mask:0xf bank_mask:0xf
v_mfma_f32_16x16x32_bf16 v[128:131], v[32:35], a[184:187], v[128:131]
v_mfma_f32_16x16x32_bf16 v[144:147], v[32:35], a[188:191], v[144:147]
s_waitcnt vmcnt(14) lgkmcnt(4)
s_barrier
v_mfma_f32_16x16x32_bf16 v[148:151], v[36:39], a[188:191], v[148:151]
s_nop 0
ds_read_b64_tr_b16 v[32:33], v16 offset:16640
ds_read_b64_tr_b16 v[34:35], v16 offset:16896
v_mfma_f32_16x16x32_bf16 v[132:135], v[36:39], a[184:187], v[132:135]
s_add_u32 m0, s38, 66560
ds_read_b128 a[200:203], v8 offset:8192
ds_read_b128 a[204:207], v8 offset:10240
v_mfma_f32_16x16x32_bf16 v[116:119], v[36:39], a[180:183], v[116:119]
s_addk_i32 s57, 128
buffer_load_dwordx4 v14, s[8:11], s57 offen offset:0 lds
v_cndmask_b32_dpp v93, v81, v85, vcc quad_perm:[2,3,0,1] row_mask:0xf bank_mask:0xf
v_mfma_f32_16x16x32_bf16 v[100:103], v[36:39], a[176:179], v[100:103]
s_waitcnt lgkmcnt(6)
v_cndmask_b32_dpp v94, v82, v86, vcc quad_perm:[2,3,0,1] row_mask:0xf bank_mask:0xf
v_cndmask_b32_dpp v95, v83, v87, vcc quad_perm:[2,3,0,1] row_mask:0xf bank_mask:0xf
v_mfma_f32_16x16x32_bf16 v[104:107], v[40:43], a[176:179], v[104:107]
s_nop 0
ds_read_b64_tr_b16 v[36:37], v16 offset:16672
ds_read_b64_tr_b16 v[38:39], v16 offset:16928
v_mfma_f32_16x16x32_bf16 v[120:123], v[40:43], a[180:183], v[120:123]
buffer_load_dwordx4 v14, s[12:15], s57 offen offset:2080 lds
buffer_store_dwordx4 v[92:95], v26, s[20:23], s1 offen sc1
v_mfma_f32_16x16x32_bf16 v[136:139], v[40:43], a[184:187], v[136:139]
v_mfma_f32_16x16x32_bf16 v[152:155], v[40:43], a[188:191], v[152:155]
s_waitcnt lgkmcnt(6)
v_mfma_f32_16x16x32_bf16 v[156:159], v[44:47], a[188:191], v[156:159]
ds_read_b64_tr_b16 v[40:41], v16 offset:18720
v_mfma_f32_16x16x32_bf16 v[140:143], v[44:47], a[184:187], v[140:143]
ds_read_b64_tr_b16 v[42:43], v16 offset:18976
v_mfma_f32_16x16x32_bf16 v[124:127], v[44:47], a[180:183], v[124:127]
s_add_u32 m0, s38, 74880
v_mfma_f32_16x16x32_bf16 v[108:111], v[44:47], a[176:179], v[108:111]
s_waitcnt lgkmcnt(4)
buffer_load_dwordx4 v15, s[8:11], s57 offen offset:0 lds
v_mfma_f32_16x16x32_bf16 v[96:99], v[32:35], a[192:195], v[96:99]
s_waitcnt vmcnt(11)
ds_read_b64_tr_b16 v[44:45], v16 offset:18752
ds_read_b64_tr_b16 v[46:47], v16 offset:19008
v_cmp_ne_u32 vcc, 1, v28
v_mfma_f32_16x16x32_bf16 v[112:115], v[32:35], a[196:199], v[112:115]
s_nop 0
ds_read_b128 a[216:219], v9 offset:8192
ds_read_b128 a[220:223], v9 offset:10240
v_mfma_f32_16x16x32_bf16 v[128:131], v[32:35], a[200:203], v[128:131]
s_cbranch_vccnz L_slow_go
L_back_go:
v_mfma_f32_16x16x32_bf16 v[144:147], v[32:35], a[204:207], v[144:147]
s_waitcnt lgkmcnt(6)
v_min_u32 v30, 1, v0
v_lshlrev_b32 v30, 30, v30
v_mfma_f32_16x16x32_bf16 v[148:151], v[36:39], a[204:207], v[148:151]
ds_read_b64_tr_b16 v[32:33], v16 offset:24960
v_mfma_f32_16x16x32_bf16 v[132:135], v[36:39], a[200:203], v[132:135]
ds_read_b64_tr_b16 v[34:35], v16 offset:25216
buffer_load_dwordx4 v15, s[12:15], s57 offen offset:2080 lds
v_mfma_f32_16x16x32_bf16 v[116:119], v[36:39], a[196:199], v[116:119]
v_mfma_f32_16x16x32_bf16 v[100:103], v[36:39], a[192:195], v[100:103]
s_waitcnt lgkmcnt(6)
v_mfma_f32_16x16x32_bf16 v[104:107], v[40:43], a[192:195], v[104:107]
ds_read_b64_tr_b16 v[36:37], v16 offset:24992
v_mfma_f32_16x16x32_bf16 v[120:123], v[40:43], a[196:199], v[120:123]
s_add_u32 m0, s39, 0
ds_read_b64_tr_b16 v[38:39], v16 offset:25248
v_mfma_f32_16x16x32_bf16 v[136:139], v[40:43], a[200:203], v[136:139]
buffer_load_dwordx4 v18, s[16:19], s63 offen offset:0 lds
v_mfma_f32_16x16x32_bf16 v[152:155], v[40:43], a[204:207], v[152:155]
s_waitcnt lgkmcnt(6)
v_mfma_f32_16x16x32_bf16 v[156:159], v[44:47], a[204:207], v[156:159]
ds_read_b64_tr_b16 v[40:41], v16 offset:27040
v_mfma_f32_16x16x32_bf16 v[140:143], v[44:47], a[200:203], v[140:143]
ds_read_b64_tr_b16 v[42:43], v16 offset:27296
v_mfma_f32_16x16x32_bf16 v[124:127], v[44:47], a[196:199], v[124:127]
v_mfma_f32_16x16x32_bf16 v[108:111], v[44:47], a[192:195], v[108:111]
s_waitcnt lgkmcnt(4)
buffer_load_dwordx4 v19, s[16:19], s63 offen offset:1024 lds
v_mfma_f32_16x16x32_bf16 v[96:99], v[32:35], a[208:211], v[96:99]
ds_read_b64_tr_b16 v[44:45], v16 offset:27072
v_mfma_f32_16x16x32_bf16 v[112:115], v[32:35], a[212:215], v[112:115]
ds_read_b64_tr_b16 v[46:47], v16 offset:27328
v_mfma_f32_16x16x32_bf16 v[128:131], v[32:35], a[216:219], v[128:131]
v_mfma_f32_16x16x32_bf16 v[144:147], v[32:35], a[220:223], v[144:147]
s_waitcnt vmcnt(12) lgkmcnt(4)
s_barrier
v_mfma_f32_16x16x32_bf16 v[148:151], v[36:39], a[220:223], v[148:151]
s_add_u32 m0, s38, 0
ds_read_b64_tr_b16 v[32:33], v16 offset:33280
ds_read_b64_tr_b16 v[34:35], v16 offset:33536
v_mfma_f32_16x16x32_bf16 v[132:135], v[36:39], a[216:219], v[132:135]
s_addk_i32 s58, 128
buffer_load_dwordx4 v14, s[8:11], s58 offen offset:0 lds
v_mfma_f32_16x16x32_bf16 v[116:119], v[36:39], a[212:215], v[116:119]
v_mfma_f32_16x16x32_bf16 v[100:103], v[36:39], a[208:211], v[100:103]
s_waitcnt lgkmcnt(4)
v_mfma_f32_16x16x32_bf16 v[104:107], v[40:43], a[208:211], v[104:107]
ds_read_b64_tr_b16 v[36:37], v16 offset:33312
v_mfma_f32_16x16x32_bf16 v[120:123], v[40:43], a[212:215], v[120:123]
ds_read_b64_tr_b16 v[38:39], v16 offset:33568
v_mfma_f32_16x16x32_bf16 v[136:139], v[40:43], a[216:219], v[136:139]
buffer_load_dwordx4 v14, s[12:15], s58 offen offset:2080 lds
v_mfma_f32_16x16x32_bf16 v[152:155], v[40:43], a[220:223], v[152:155]
s_waitcnt lgkmcnt(4)
v_mfma_f32_16x16x32_bf16 v[156:159], v[44:47], a[220:223], v[156:159]
ds_read_b64_tr_b16 v[40:41], v16 offset:35360
v_mfma_f32_16x16x32_bf16 v[140:143], v[44:47], a[216:219], v[140:143]
ds_read_b64_tr_b16 v[42:43], v16 offset:35616
v_mfma_f32_16x16x32_bf16 v[124:127], v[44:47], a[212:215], v[124:127]
v_mfma_f32_16x16x32_bf16 v[108:111], v[44:47], a[208:211], v[108:111]
s_waitcnt lgkmcnt(4)
v_pk_mul_f32 v[248:249], v[96:97], s[44:45]
s_add_u32 m0, s38, 8320
s_nop 0
buffer_load_dwordx4 v15, s[8:11], s58 offen offset:0 lds
v_pk_mul_f32 v[250:251], v[98:99], s[44:45]
v_pk_mul_f32 v[252:253], v[100:101], s[44:45]
v_pk_mul_f32 v[254:255], v[102:103], s[44:45]
v_exp_f32 v248, v248
buffer_load_dwordx4 v15, s[12:15], s58 offen offset:2080 lds
v_exp_f32 v249, v249
v_exp_f32 v250, v250
v_exp_f32 v251, v251
v_exp_f32 v252, v252
v_exp_f32 v253, v253
v_exp_f32 v254, v254
s_add_u32 m0, s39, 0
s_nop 0
buffer_load_dwordx4 v20, s[16:19], s63 offen offset:2048 lds
v_exp_f32 v255, v255
v_pk_mul_f32 v[104:105], v[96:97], v[104:105]
v_pk_mul_f32 v[106:107], v[98:99], v[106:107]
v_pk_mul_f32 v[108:109], v[100:101], v[108:109]
v_pk_mul_f32 v[110:111], v[102:103], v[110:111]
v_pk_add_f32 v[248:249], v[248:249], 1.0 op_sel_hi:[1,0]
v_pk_add_f32 v[250:251], v[250:251], 1.0 op_sel_hi:[1,0]
v_pk_add_f32 v[252:253], v[252:253], 1.0 op_sel_hi:[1,0]
v_pk_add_f32 v[254:255], v[254:255], 1.0 op_sel_hi:[1,0]
v_rcp_f32 v248, v248
buffer_load_dwordx4 v21, s[16:19], s63 offen offset:3072 lds
v_rcp_f32 v249, v249
v_rcp_f32 v250, v250
v_rcp_f32 v251, v251
v_rcp_f32 v252, v252
v_rcp_f32 v253, v253
v_rcp_f32 v254, v254
v_rcp_f32 v255, v255
v_pk_mul_f32 v[104:105], v[104:105], v[248:249]
v_pk_mul_f32 v[106:107], v[106:107], v[250:251]
v_pk_mul_f32 v[108:109], v[108:109], v[252:253]
v_pk_mul_f32 v[110:111], v[110:111], v[254:255]
v_cvt_pk_bf16_f32 v96, v104, v105
v_cvt_pk_bf16_f32 v97, v106, v107
v_cvt_pk_bf16_f32 v98, v108, v109
v_cvt_pk_bf16_f32 v99, v110, v111
buffer_store_dwordx4 v[96:99], v1, s[20:23], s69 offen offset:0 sc1
v_pk_mul_f32 v[248:249], v[112:113], s[44:45]
v_pk_mul_f32 v[250:251], v[114:115], s[44:45]
v_pk_mul_f32 v[252:253], v[116:117], s[44:45]
v_pk_mul_f32 v[254:255], v[118:119], s[44:45]
v_exp_f32 v248, v248
v_exp_f32 v249, v249
v_exp_f32 v250, v250
v_exp_f32 v251, v251
v_exp_f32 v252, v252
v_exp_f32 v253, v253
v_exp_f32 v254, v254
v_exp_f32 v255, v255
v_pk_mul_f32 v[120:121], v[112:113], v[120:121]
v_pk_mul_f32 v[122:123], v[114:115], v[122:123]
v_pk_mul_f32 v[124:125], v[116:117], v[124:125]
v_pk_mul_f32 v[126:127], v[118:119], v[126:127]
v_pk_add_f32 v[248:249], v[248:249], 1.0 op_sel_hi:[1,0]
v_pk_add_f32 v[250:251], v[250:251], 1.0 op_sel_hi:[1,0]
v_pk_add_f32 v[252:253], v[252:253], 1.0 op_sel_hi:[1,0]
v_pk_add_f32 v[254:255], v[254:255], 1.0 op_sel_hi:[1,0]
v_rcp_f32 v248, v248
v_rcp_f32 v249, v249
v_rcp_f32 v250, v250
v_rcp_f32 v251, v251
v_rcp_f32 v252, v252
v_rcp_f32 v253, v253
v_rcp_f32 v254, v254
v_rcp_f32 v255, v255
v_pk_mul_f32 v[120:121], v[120:121], v[248:249]
v_pk_mul_f32 v[122:123], v[122:123], v[250:251]
v_pk_mul_f32 v[124:125], v[124:125], v[252:253]
v_pk_mul_f32 v[126:127], v[126:127], v[254:255]
v_cvt_pk_bf16_f32 v112, v120, v121
v_cvt_pk_bf16_f32 v113, v122, v123
v_cvt_pk_bf16_f32 v114, v124, v125
v_cvt_pk_bf16_f32 v115, v126, v127
buffer_store_dwordx4 v[112:115], v1, s[20:23], s69 offen offset:1024 sc1
v_pk_mul_f32 v[248:249], v[128:129], s[44:45]
v_pk_mul_f32 v[250:251], v[130:131], s[44:45]
v_pk_mul_f32 v[252:253], v[132:133], s[44:45]
v_pk_mul_f32 v[254:255], v[134:135], s[44:45]
v_exp_f32 v248, v248
v_exp_f32 v249, v249
v_exp_f32 v250, v250
v_exp_f32 v251, v251
v_exp_f32 v252, v252
v_exp_f32 v253, v253
v_exp_f32 v254, v254
v_exp_f32 v255, v255
v_pk_mul_f32 v[136:137], v[128:129], v[136:137]
v_pk_mul_f32 v[138:139], v[130:131], v[138:139]
v_pk_mul_f32 v[140:141], v[132:133], v[140:141]
v_pk_mul_f32 v[142:143], v[134:135], v[142:143]
v_pk_add_f32 v[248:249], v[248:249], 1.0 op_sel_hi:[1,0]
v_pk_add_f32 v[250:251], v[250:251], 1.0 op_sel_hi:[1,0]
L_pad1:
s_cbranch_execz L_padret
v_pk_add_f32 v[252:253], v[252:253], 1.0 op_sel_hi:[1,0]
v_pk_add_f32 v[254:255], v[254:255], 1.0 op_sel_hi:[1,0]
v_rcp_f32 v248, v248
v_rcp_f32 v249, v249
v_rcp_f32 v250, v250
v_rcp_f32 v251, v251
v_rcp_f32 v252, v252
v_rcp_f32 v253, v253
v_rcp_f32 v254, v254
v_rcp_f32 v255, v255
v_pk_mul_f32 v[136:137], v[136:137], v[248:249]
v_pk_mul_f32 v[138:139], v[138:139], v[250:251]
v_pk_mul_f32 v[140:141], v[140:141], v[252:253]
v_pk_mul_f32 v[142:143], v[142:143], v[254:255]
v_cvt_pk_bf16_f32 v128, v136, v137
v_cvt_pk_bf16_f32 v129, v138, v139
v_cvt_pk_bf16_f32 v130, v140, v141
v_cvt_pk_bf16_f32 v131, v142, v143
buffer_store_dwordx4 v[128:131], v1, s[20:23], s3 offen offset:0 sc1
v_pk_mul_f32 v[248:249], v[144:145], s[44:45]
v_pk_mul_f32 v[250:251], v[146:147], s[44:45]
v_pk_mul_f32 v[252:253], v[148:149], s[44:45]
v_pk_mul_f32 v[254:255], v[150:151], s[44:45]
v_exp_f32 v248, v248
v_exp_f32 v249, v249
v_exp_f32 v250, v250
v_exp_f32 v251, v251
v_exp_f32 v252, v252
v_exp_f32 v253, v253
v_exp_f32 v254, v254
v_exp_f32 v255, v255
v_pk_mul_f32 v[152:153], v[144:145], v[152:153]
v_pk_mul_f32 v[154:155], v[146:147], v[154:155]
v_pk_mul_f32 v[156:157], v[148:149], v[156:157]
v_pk_mul_f32 v[158:159], v[150:151], v[158:159]
v_pk_add_f32 v[248:249], v[248:249], 1.0 op_sel_hi:[1,0]
v_pk_add_f32 v[250:251], v[250:251], 1.0 op_sel_hi:[1,0]
v_pk_add_f32 v[252:253], v[252:253], 1.0 op_sel_hi:[1,0]
v_pk_add_f32 v[254:255], v[254:255], 1.0 op_sel_hi:[1,0]
v_rcp_f32 v248, v248
v_rcp_f32 v249, v249
v_rcp_f32 v250, v250
v_rcp_f32 v251, v251
s_add_u32 m0, s39, 4096
s_nop 0
buffer_load_dwordx4 v18, s[16:19], s64 offen offset:0 lds
v_rcp_f32 v252, v252
v_rcp_f32 v253, v253
buffer_load_dwordx4 v19, s[16:19], s64 offen offset:1024 lds
v_rcp_f32 v254, v254
v_rcp_f32 v255, v255
v_pk_mul_f32 v[152:153], v[152:153], v[248:249]
v_pk_mul_f32 v[154:155], v[154:155], v[250:251]
v_pk_mul_f32 v[156:157], v[156:157], v[252:253]
v_pk_mul_f32 v[158:159], v[158:159], v[254:255]
v_cvt_pk_bf16_f32 v144, v152, v153
v_cvt_pk_bf16_f32 v145, v154, v155
v_cvt_pk_bf16_f32 v146, v156, v157
v_cvt_pk_bf16_f32 v147, v158, v159
buffer_store_dwordx4 v[144:147], v1, s[20:23], s3 offen offset:1024 sc1
v_mfma_f32_16x16x32_bf16 v[96:99], v[32:35], a[0:3], 0
s_mov_b32 s4, 0
ds_read_b64_tr_b16 v[44:45], v16 offset:35392
ds_read_b64_tr_b16 v[46:47], v16 offset:35648
v_mfma_f32_16x16x32_bf16 v[112:115], v[32:35], a[4:7], 0
s_add_u32 s5, s4, 4096
v_cos_f32 v192, v196
v_mfma_f32_16x16x32_bf16 v[128:131], v[32:35], a[8:11], 0
s_sub_u32 s73, s5, 28672
v_cvt_pk_bf16_f32 v216, v200, v201
v_cvt_pk_bf16_f32 v217, v202, v203
v_mfma_f32_16x16x32_bf16 v[144:147], v[32:35], a[12:15], 0
s_waitcnt lgkmcnt(4)
v_cvt_pk_bf16_f32 v218, v204, v205
v_cvt_pk_bf16_f32 v219, v206, v207
v_mfma_f32_16x16x32_bf16 v[148:151], v[36:39], a[12:15], 0
s_min_u32 s5, s5, s73
ds_read_b64_tr_b16 v[32:33], v16 offset:41600
ds_read_b64_tr_b16 v[34:35], v16 offset:41856
v_mfma_f32_16x16x32_bf16 v[132:135], v[36:39], a[8:11], 0
s_add_u32 s6, s5, 4096
buffer_load_dwordx4 v20, s[16:19], s64 offen offset:2048 lds
v_cvt_pk_bf16_f32 v228, v208, v209
v_mfma_f32_16x16x32_bf16 v[116:119], v[36:39], a[4:7], 0
s_sub_u32 s73, s6, 28672
v_cvt_pk_bf16_f32 v229, v210, v211
v_cvt_pk_bf16_f32 v230, v212, v213
v_mfma_f32_16x16x32_bf16 v[100:103], v[36:39], a[0:3], 0
s_waitcnt lgkmcnt(4)
v_cvt_pk_bf16_f32 v231, v214, v215
v_accvgpr_write_b32 a252, v216
v_mfma_f32_16x16x32_bf16 v[104:107], v[40:43], a[0:3], 0
s_min_u32 s6, s6, s73
ds_read_b64_tr_b16 v[36:37], v16 offset:41632
ds_read_b64_tr_b16 v[38:39], v16 offset:41888
v_mfma_f32_16x16x32_bf16 v[120:123], v[40:43], a[4:7], 0
s_waitcnt vmcnt(17)
buffer_store_dword v28, v30, s[20:23], s0 offen sc1
v_accvgpr_write_b32 a253, v217
v_mfma_f32_16x16x32_bf16 v[136:139], v[40:43], a[8:11], 0
s_add_u32 s7, s6, 4096
buffer_load_dwordx4 v21, s[16:19], s64 offen offset:3072 lds
v_accvgpr_write_b32 a254, v218
v_mfma_f32_16x16x32_bf16 v[152:155], v[40:43], a[12:15], 0
s_waitcnt lgkmcnt(4)
v_accvgpr_write_b32 a255, v219
v_mul_f32 v197, v198, v196
v_mfma_f32_16x16x32_bf16 v[156:159], v[44:47], a[12:15], 0
s_sub_u32 s73, s7, 28672
ds_read_b64_tr_b16 v[40:41], v16 offset:43680
ds_read_b64_tr_b16 v[42:43], v16 offset:43936
v_mfma_f32_16x16x32_bf16 v[140:143], v[44:47], a[8:11], 0
s_min_u32 s7, s7, s73
v_cos_f32 v68, v197
v_mfma_f32_16x16x32_bf16 v[124:127], v[44:47], a[4:7], 0
s_add_u32 s28, s7, 4096
v_sin_f32 v76, v197
v_mfma_f32_16x16x32_bf16 v[108:111], v[44:47], a[0:3], 0
s_waitcnt lgkmcnt(4)
v_add_f32 v192, v192, v192
v_add_f32 v77, v197, v196
v_mfma_f32_16x16x32_bf16 v[96:99], v[32:35], a[16:19], v[96:99]
s_sub_u32 s73, s28, 28672
ds_read_b64_tr_b16 v[44:45], v16 offset:43712
ds_read_b64_tr_b16 v[46:47], v16 offset:43968
v_mfma_f32_16x16x32_bf16 v[112:115], v[32:35], a[20:23], v[112:115]
s_min_u32 s28, s28, s73
v_cos_f32 v69, v77
v_mfma_f32_16x16x32_bf16 v[128:131], v[32:35], a[24:27], v[128:131]
s_nop 0
ds_read_b64_tr_b16 a[0:1], v10 offset:12288
ds_read_b64_tr_b16 a[2:3], v10 offset:14336
v_mfma_f32_16x16x32_bf16 v[144:147], v[32:35], a[28:31], v[144:147]
s_waitcnt lgkmcnt(6)
s_barrier
v_mfma_f32_16x16x32_bf16 v[148:151], v[36:39], a[28:31], v[148:151]
s_add_u32 m0, s38, 16640
ds_read_b64_tr_b16 v[32:33], v16 offset:49920
ds_read_b64_tr_b16 v[34:35], v16 offset:50176
v_mfma_f32_16x16x32_bf16 v[132:135], v[36:39], a[24:27], v[132:135]
s_addk_i32 s59, 128
buffer_load_dwordx4 v14, s[8:11], s59 offen offset:0 lds
ds_read_b64_tr_b16 a[4:5], v11 offset:12288
v_mfma_f32_16x16x32_bf16 v[116:119], v[36:39], a[20:23], v[116:119]
s_add_u32 s29, s28, 4096
ds_read_b64_tr_b16 a[6:7], v11 offset:14336
ds_read_b64_tr_b16 a[8:9], v12 offset:12288
v_mfma_f32_16x16x32_bf16 v[100:103], v[36:39], a[16:19], v[100:103]
s_waitcnt lgkmcnt(9)
buffer_load_dwordx4 v14, s[12:15], s59 offen offset:2080 lds
ds_read_b64_tr_b16 a[10:11], v12 offset:14336
v_mfma_f32_16x16x32_bf16 v[104:107], v[40:43], a[16:19], v[104:107]
s_sub_u32 s73, s29, 28672
ds_read_b64_tr_b16 v[36:37], v16 offset:49952
ds_read_b64_tr_b16 v[38:39], v16 offset:50208
v_mfma_f32_16x16x32_bf16 v[120:123], v[40:43], a[20:23], v[120:123]
s_min_u32 s29, s29, s73
v_sin_f32 v77, v77
v_mfma_f32_16x16x32_bf16 v[136:139], v[40:43], a[24:27], v[136:139]
s_add_u32 m0, s38, 24960
ds_read_b64_tr_b16 a[12:13], v13 offset:12288
ds_read_b64_tr_b16 a[14:15], v13 offset:14336
v_mfma_f32_16x16x32_bf16 v[152:155], v[40:43], a[28:31], v[152:155]
s_waitcnt lgkmcnt(12)
buffer_load_dwordx4 v15, s[8:11], s59 offen offset:0 lds
v_mul_f32 v68, s71, v68
v_mfma_f32_16x16x32_bf16 v[156:159], v[44:47], a[28:31], v[156:159]
s_add_u32 s30, s29, 4096
ds_read_b64_tr_b16 v[40:41], v16 offset:52000
ds_read_b64_tr_b16 v[42:43], v16 offset:52256
v_mfma_f32_16x16x32_bf16 v[140:143], v[44:47], a[24:27], v[140:143]
s_sub_u32 s73, s30, 28672
v_mul_f32 v76, s71, v76
v_mul_f32 v69, s71, v69
v_mfma_f32_16x16x32_bf16 v[124:127], v[44:47], a[20:23], v[124:127]
s_min_u32 s30, s30, s73
v_mul_f32 v77, s71, v77
v_fma_f32 v70, v192, v69, -v68
v_mfma_f32_16x16x32_bf16 v[108:111], v[44:47], a[16:19], v[108:111]
s_waitcnt lgkmcnt(10)
buffer_load_dwordx4 v15, s[12:15], s59 offen offset:2080 lds
ds_read_b64_tr_b16 a[16:17], v10 offset:28672
v_mfma_f32_16x16x32_bf16 v[96:99], v[32:35], a[32:35], v[96:99]
s_and_b32 s1, s32, 1
ds_read_b64_tr_b16 v[44:45], v16 offset:52032
ds_read_b64_tr_b16 v[46:47], v16 offset:52288
v_mfma_f32_16x16x32_bf16 v[112:115], v[32:35], a[36:39], v[112:115]
s_lshr_b32 s49, s32, 1
v_fma_f32 v78, v192, v77, -v76
v_fma_f32 v71, v192, v70, -v69
v_mfma_f32_16x16x32_bf16 v[128:131], v[32:35], a[40:43], v[128:131]
s_add_u32 m0, s39, 8192
ds_read_b64_tr_b16 a[18:19], v10 offset:30720
ds_read_b64_tr_b16 a[20:21], v11 offset:28672
v_mfma_f32_16x16x32_bf16 v[144:147], v[32:35], a[44:47], v[144:147]
s_waitcnt lgkmcnt(9)
buffer_load_dwordx4 v18, s[16:19], s65 offen offset:0 lds
ds_read_b64_tr_b16 a[22:23], v11 offset:30720
v_mfma_f32_16x16x32_bf16 v[148:151], v[36:39], a[44:47], v[148:151]
s_mul_i32 s53, s32, 14336
ds_read_b64_tr_b16 v[32:33], v16 offset:58240
ds_read_b64_tr_b16 v[34:35], v16 offset:58496
v_mfma_f32_16x16x32_bf16 v[132:135], v[36:39], a[40:43], v[132:135]
s_add_u32 s53, s53, 25856
v_fma_f32 v79, v192, v78, -v77
v_add_u32 v25, s39, v1
v_mfma_f32_16x16x32_bf16 v[116:119], v[36:39], a[36:39], v[116:119]
s_xor_b32 s76, s32, 2
ds_read_b64_tr_b16 a[24:25], v12 offset:28672
ds_read_b64_tr_b16 a[26:27], v12 offset:30720
v_mfma_f32_16x16x32_bf16 v[100:103], v[36:39], a[32:35], v[100:103]
s_waitcnt lgkmcnt(10)
buffer_load_dwordx4 v19, s[16:19], s65 offen offset:1024 lds
ds_read_b64_tr_b16 a[28:29], v13 offset:28672
v_mfma_f32_16x16x32_bf16 v[104:107], v[40:43], a[32:35], v[104:107]
s_lshl_b32 s76, s76, 14
ds_read_b64_tr_b16 v[36:37], v16 offset:58272
ds_read_b64_tr_b16 v[38:39], v16 offset:58528
v_mfma_f32_16x16x32_bf16 v[120:123], v[40:43], a[36:39], v[120:123]
s_add_u32 s76, s76, 83200
v_add_u32 v26, s76, v1
s_xor_b32 s76, s32, 1
v_mfma_f32_16x16x32_bf16 v[136:139], v[40:43], a[40:43], v[136:139]
s_lshl_b32 s76, s76, 14
ds_read_b64_tr_b16 a[30:31], v13 offset:30720
s_add_u32 s76, s76, 83200
v_mfma_f32_16x16x32_bf16 v[152:155], v[40:43], a[44:47], v[152:155]
s_waitcnt lgkmcnt(11)
buffer_load_dwordx4 v20, s[16:19], s65 offen offset:2048 lds
v_add_u32 v5, s76, v1
v_mfma_f32_16x16x32_bf16 v[156:159], v[44:47], a[44:47], v[156:159]
s_lshl_b32 s51, s32, 8
ds_read_b64_tr_b16 v[40:41], v16 offset:60320
ds_read_b64_tr_b16 v[42:43], v16 offset:60576
v_mfma_f32_16x16x32_bf16 v[140:143], v[44:47], a[40:43], v[140:143]
s_add_u32 s76, s51, s35
s_add_u32 s51, s51, s37
s_lshl_b32 s51, s51, 5
v_mfma_f32_16x16x32_bf16 v[124:127], v[44:47], a[36:39], v[124:127]
s_add_u32 s51, s51, 163840
s_lshl_b32 s76, s76, 7
s_add_u32 s76, s76, 2883584
v_mfma_f32_16x16x32_bf16 v[108:111], v[44:47], a[32:35], v[108:111]
s_waitcnt lgkmcnt(8)
buffer_load_dwordx4 v21, s[16:19], s65 offen offset:3072 lds
v_add_u32 v23, s76, v23
v_mfma_f32_16x16x32_bf16 v[96:99], v[32:35], a[48:51], v[96:99]
s_lshl_b32 s76, s1, 9
ds_read_b64_tr_b16 v[44:45], v16 offset:60352
ds_read_b64_tr_b16 v[46:47], v16 offset:60608
v_mfma_f32_16x16x32_bf16 v[112:115], v[32:35], a[52:55], v[112:115]
s_add_u32 s76, s76, 25856
v_lshrrev_b32 v246, 5, v0
v_mul_u32_u24 v247, 14336, v246
v_mfma_f32_16x16x32_bf16 v[128:131], v[32:35], a[56:59], v[128:131]
v_mfma_f32_16x16x32_bf16 v[144:147], v[32:35], a[60:63], v[144:147]
s_waitcnt vmcnt(17) lgkmcnt(4)
s_barrier
v_mfma_f32_16x16x32_bf16 v[148:151], v[36:39], a[60:63], v[148:151]
s_add_u32 m0, s39, 12288
ds_read_b64_tr_b16 v[32:33], v17 offset:0
ds_read_b64_tr_b16 v[34:35], v17 offset:256
v_mfma_f32_16x16x32_bf16 v[132:135], v[36:39], a[56:59], v[132:135]
s_and_b32 s47, s35, 1
buffer_load_dwordx4 v18, s[16:19], s66 offen offset:0 lds
ds_read_b64_tr_b16 a[32:33], v10 offset:0
v_mfma_f32_16x16x32_bf16 v[116:119], v[36:39], a[52:55], v[116:119]
s_lshl1_add_u32 s49, s36, s49
ds_read_b64_tr_b16 a[34:35], v10 offset:2048
ds_read_b64_tr_b16 a[36:37], v11 offset:0
v_mfma_f32_16x16x32_bf16 v[100:103], v[36:39], a[48:51], v[100:103]
s_waitcnt lgkmcnt(7)
buffer_load_dwordx4 v19, s[16:19], s66 offen offset:1024 lds
ds_read_b64_tr_b16 a[38:39], v11 offset:2048
v_mfma_f32_16x16x32_bf16 v[104:107], v[40:43], a[48:51], v[104:107]
s_nop 0
ds_read_b64_tr_b16 v[36:37], v17 offset:32
ds_read_b64_tr_b16 v[38:39], v17 offset:288
v_mfma_f32_16x16x32_bf16 v[120:123], v[40:43], a[52:55], v[120:123]
s_waitcnt vmcnt(13)
buffer_store_dword v28, v30, s[20:23], s79 offen sc1
v_add3_u32 v22, v22, v247, s76
v_mfma_f32_16x16x32_bf16 v[136:139], v[40:43], a[56:59], v[136:139]
s_lshr_b32 s76, s35, 3
ds_read_b64_tr_b16 a[40:41], v12 offset:0
ds_read_b64_tr_b16 a[42:43], v12 offset:2048
v_mfma_f32_16x16x32_bf16 v[152:155], v[40:43], a[60:63], v[152:155]
s_waitcnt lgkmcnt(10)
buffer_load_dwordx4 v20, s[16:19], s66 offen offset:2048 lds
ds_read_b64_tr_b16 a[44:45], v13 offset:0
v_mfma_f32_16x16x32_bf16 v[156:159], v[44:47], a[60:63], v[156:159]
s_lshl1_add_u32 s76, s76, s47
ds_read_b64_tr_b16 v[40:41], v17 offset:2080
ds_read_b64_tr_b16 v[42:43], v17 offset:2336
v_mfma_f32_16x16x32_bf16 v[140:143], v[44:47], a[56:59], v[140:143]
s_lshl1_add_u32 s76, s76, s1
v_xor_b32 v6, 32, v22
s_bfe_u32 s47, s35, 0x20001
v_mfma_f32_16x16x32_bf16 v[124:127], v[44:47], a[52:55], v[124:127]
s_lshl4_add_u32 s76, s76, s47
ds_read_b64_tr_b16 a[46:47], v13 offset:2048
s_mul_i32 s76, s76, 7168
v_mfma_f32_16x16x32_bf16 v[108:111], v[44:47], a[48:51], v[108:111]
s_waitcnt lgkmcnt(12)
buffer_load_dwordx4 v21, s[16:19], s66 offen offset:3072 lds
ds_read_b64_tr_b16 a[48:49], v10 offset:16384
v_mfma_f32_16x16x32_bf16 v[96:99], v[32:35], a[64:67], v[96:99]
s_lshl_b32 s47, s49, 6
ds_read_b64_tr_b16 v[44:45], v17 offset:2112
ds_read_b64_tr_b16 v[46:47], v17 offset:2368
v_mfma_f32_16x16x32_bf16 v[112:115], v[32:35], a[68:71], v[112:115]
s_addk_i32 s60, 128
s_add_u32 s76, s76, s47
v_bfe_u32 v247, v0, 2, 3
v_mfma_f32_16x16x32_bf16 v[128:131], v[32:35], a[72:75], v[128:131]
s_add_u32 m0, s38, 33280
s_waitcnt lgkmcnt(10)
ds_read_b64_tr_b16 a[50:51], v10 offset:18432
ds_read_b64_tr_b16 a[52:53], v11 offset:16384
v_mfma_f32_16x16x32_bf16 v[144:147], v[32:35], a[76:79], v[144:147]
s_waitcnt lgkmcnt(11)
buffer_load_dwordx4 v14, s[8:11], s60 offen offset:0 lds
ds_read_b64_tr_b16 a[54:55], v11 offset:18432
v_mfma_f32_16x16x32_bf16 v[148:151], v[36:39], a[76:79], v[148:151]
s_lshl1_add_u32 s78, s35, s1
ds_read_b64_tr_b16 v[32:33], v17 offset:8320
ds_read_b64_tr_b16 v[34:35], v17 offset:8576
v_mfma_f32_16x16x32_bf16 v[132:135], v[36:39], a[72:75], v[132:135]
s_lshl_b32 s78, s78, 7
v_lshl_add_u32 v247, v246, 5, v247
v_mul_u32_u24 v247, 896, v247
v_mfma_f32_16x16x32_bf16 v[116:119], v[36:39], a[68:71], v[116:119]
s_add_u32 s78, s78, 253952
ds_read_b64_tr_b16 a[56:57], v12 offset:16384
s_waitcnt lgkmcnt(10)
ds_read_b64_tr_b16 a[58:59], v12 offset:18432
v_mfma_f32_16x16x32_bf16 v[100:103], v[36:39], a[64:67], v[100:103]
buffer_load_dwordx4 v14, s[12:15], s60 offen offset:2080 lds
ds_read_b64_tr_b16 a[60:61], v13 offset:16384
v_mfma_f32_16x16x32_bf16 v[104:107], v[40:43], a[64:67], v[104:107]
s_waitcnt lgkmcnt(10)
ds_read_b64_tr_b16 v[36:37], v17 offset:8352
ds_read_b64_tr_b16 v[38:39], v17 offset:8608
v_mfma_f32_16x16x32_bf16 v[120:123], v[40:43], a[68:71], v[120:123]
v_and_b32 v246, 48, v1
v_add3_u32 v24, v246, v247, s76
v_mfma_f32_16x16x32_bf16 v[136:139], v[40:43], a[72:75], v[136:139]
s_add_u32 m0, s38, 41600
ds_read_b64_tr_b16 a[62:63], v13 offset:18432
v_and_b32 v7, 15, v0
v_mfma_f32_16x16x32_bf16 v[152:155], v[40:43], a[76:79], v[152:155]
s_waitcnt lgkmcnt(11)
buffer_load_dwordx4 v15, s[8:11], s60 offen offset:0 lds
v_lshlrev_b32 v7, 2, v7
v_mfma_f32_16x16x32_bf16 v[156:159], v[44:47], a[76:79], v[156:159]
ds_read_b64_tr_b16 v[40:41], v17 offset:10400
v_mfma_f32_16x16x32_bf16 v[140:143], v[44:47], a[72:75], v[140:143]
ds_read_b64_tr_b16 v[42:43], v17 offset:10656
buffer_load_dword v29, v27, s[20:23], 0 offen sc1
v_mfma_f32_16x16x32_bf16 v[124:127], v[44:47], a[68:71], v[124:127]
v_mfma_f32_16x16x32_bf16 v[108:111], v[44:47], a[64:67], v[108:111]
s_waitcnt lgkmcnt(8)
buffer_load_dwordx4 v15, s[12:15], s60 offen offset:2080 lds
v_mfma_f32_16x16x32_bf16 v[96:99], v[32:35], a[80:83], v[96:99]
ds_read_b64_tr_b16 v[44:45], v17 offset:10432
v_mfma_f32_16x16x32_bf16 v[112:115], v[32:35], a[84:87], v[112:115]
ds_read_b64_tr_b16 v[46:47], v17 offset:10688
v_mfma_f32_16x16x32_bf16 v[128:131], v[32:35], a[88:91], v[128:131]
v_mfma_f32_16x16x32_bf16 v[144:147], v[32:35], a[92:95], v[144:147]
s_waitcnt vmcnt(18) lgkmcnt(4)
s_barrier
v_mfma_f32_16x16x32_bf16 v[148:151], v[36:39], a[92:95], v[148:151]
s_add_u32 m0, s39, 0
ds_read_b64_tr_b16 v[32:33], v16 offset:0
ds_read_b64_tr_b16 v[34:35], v16 offset:256
v_mfma_f32_16x16x32_bf16 v[132:135], v[36:39], a[88:91], v[132:135]
buffer_load_dwordx4 v18, s[16:19], s67 offen offset:0 lds
ds_read_b64_tr_b16 a[64:65], v10 offset:4096
v_mfma_f32_16x16x32_bf16 v[116:119], v[36:39], a[84:87], v[116:119]
s_nop 0
ds_read_b64_tr_b16 a[66:67], v10 offset:6144
ds_read_b64_tr_b16 a[68:69], v11 offset:4096
v_mfma_f32_16x16x32_bf16 v[100:103], v[36:39], a[80:83], v[100:103]
s_waitcnt lgkmcnt(7)
buffer_load_dwordx4 v19, s[16:19], s67 offen offset:1024 lds
ds_read_b64_tr_b16 a[70:71], v11 offset:6144
v_mfma_f32_16x16x32_bf16 v[104:107], v[40:43], a[80:83], v[104:107]
ds_read_b64_tr_b16 v[36:37], v16 offset:32
v_mfma_f32_16x16x32_bf16 v[120:123], v[40:43], a[84:87], v[120:123]
ds_read_b64_tr_b16 v[38:39], v16 offset:288
v_mfma_f32_16x16x32_bf16 v[136:139], v[40:43], a[88:91], v[136:139]
s_nop 0
ds_read_b64_tr_b16 a[72:73], v12 offset:4096
ds_read_b64_tr_b16 a[74:75], v12 offset:6144
v_mfma_f32_16x16x32_bf16 v[152:155], v[40:43], a[92:95], v[152:155]
s_waitcnt lgkmcnt(10)
buffer_load_dwordx4 v20, s[16:19], s67 offen offset:2048 lds
ds_read_b64_tr_b16 a[76:77], v13 offset:4096
v_mfma_f32_16x16x32_bf16 v[156:159], v[44:47], a[92:95], v[156:159]
ds_read_b64_tr_b16 v[40:41], v16 offset:2080
v_mfma_f32_16x16x32_bf16 v[140:143], v[44:47], a[88:91], v[140:143]
ds_read_b64_tr_b16 v[42:43], v16 offset:2336
v_mfma_f32_16x16x32_bf16 v[124:127], v[44:47], a[84:87], v[124:127]
ds_read_b64_tr_b16 a[78:79], v13 offset:6144
v_mfma_f32_16x16x32_bf16 v[108:111], v[44:47], a[80:83], v[108:111]
s_waitcnt lgkmcnt(12)
buffer_load_dwordx4 v21, s[16:19], s67 offen offset:3072 lds
ds_read_b64_tr_b16 a[80:81], v10 offset:20480
v_mfma_f32_16x16x32_bf16 v[96:99], v[32:35], a[96:99], v[96:99]
ds_read_b64_tr_b16 v[44:45], v16 offset:2112
v_mfma_f32_16x16x32_bf16 v[112:115], v[32:35], a[100:103], v[112:115]
s_addk_i32 s61, 128
ds_read_b64_tr_b16 v[46:47], v16 offset:2368
v_mfma_f32_16x16x32_bf16 v[128:131], v[32:35], a[104:107], v[128:131]
s_add_u32 m0, s38, 49920
s_waitcnt lgkmcnt(10)
ds_read_b64_tr_b16 a[82:83], v10 offset:22528
ds_read_b64_tr_b16 a[84:85], v11 offset:20480
v_mfma_f32_16x16x32_bf16 v[144:147], v[32:35], a[108:111], v[144:147]
s_waitcnt lgkmcnt(11)
buffer_load_dwordx4 v14, s[8:11], s61 offen offset:0 lds
ds_read_b64_tr_b16 a[86:87], v11 offset:22528
v_mfma_f32_16x16x32_bf16 v[148:151], v[36:39], a[108:111], v[148:151]
ds_read_b64_tr_b16 v[32:33], v16 offset:8320
v_mfma_f32_16x16x32_bf16 v[132:135], v[36:39], a[104:107], v[132:135]
ds_read_b64_tr_b16 v[34:35], v16 offset:8576
v_mfma_f32_16x16x32_bf16 v[116:119], v[36:39], a[100:103], v[116:119]
s_waitcnt lgkmcnt(10)
ds_read_b64_tr_b16 a[88:89], v12 offset:20480
ds_read_b64_tr_b16 a[90:91], v12 offset:22528
v_mfma_f32_16x16x32_bf16 v[100:103], v[36:39], a[96:99], v[100:103]
s_waitcnt lgkmcnt(11)
buffer_load_dwordx4 v14, s[12:15], s61 offen offset:2080 lds
ds_read_b64_tr_b16 a[92:93], v13 offset:20480
v_mfma_f32_16x16x32_bf16 v[104:107], v[40:43], a[96:99], v[104:107]
ds_read_b64_tr_b16 v[36:37], v16 offset:8352
v_mfma_f32_16x16x32_bf16 v[120:123], v[40:43], a[100:103], v[120:123]
ds_read_b64_tr_b16 v[38:39], v16 offset:8608
v_mfma_f32_16x16x32_bf16 v[136:139], v[40:43], a[104:107], v[136:139]
s_add_u32 m0, s38, 58240
ds_read_b64_tr_b16 a[94:95], v13 offset:22528
v_mfma_f32_16x16x32_bf16 v[152:155], v[40:43], a[108:111], v[152:155]
s_waitcnt lgkmcnt(11)
buffer_load_dwordx4 v15, s[8:11], s61 offen offset:0 lds
v_mfma_f32_16x16x32_bf16 v[156:159], v[44:47], a[108:111], v[156:159]
ds_read_b64_tr_b16 v[40:41], v16 offset:10400
v_mfma_f32_16x16x32_bf16 v[140:143], v[44:47], a[104:107], v[140:143]
ds_read_b64_tr_b16 v[42:43], v16 offset:10656
v_mfma_f32_16x16x32_bf16 v[124:127], v[44:47], a[100:103], v[124:127]
v_mfma_f32_16x16x32_bf16 v[108:111], v[44:47], a[96:99], v[108:111]
s_waitcnt lgkmcnt(8)
buffer_load_dwordx4 v15, s[12:15], s61 offen offset:2080 lds
v_mfma_f32_16x16x32_bf16 v[96:99], v[32:35], a[112:115], v[96:99]
ds_read_b64_tr_b16 v[44:45], v16 offset:10432
v_mfma_f32_16x16x32_bf16 v[112:115], v[32:35], a[116:119], v[112:115]
ds_read_b64_tr_b16 v[46:47], v16 offset:10688
v_mfma_f32_16x16x32_bf16 v[128:131], v[32:35], a[120:123], v[128:131]
s_add_u32 m0, s39, 4096
v_mfma_f32_16x16x32_bf16 v[144:147], v[32:35], a[124:127], v[144:147]
s_waitcnt vmcnt(18) lgkmcnt(4)
s_barrier
v_mfma_f32_16x16x32_bf16 v[148:151], v[36:39], a[124:127], v[148:151]
s_waitcnt vmcnt(9)
ds_read_b64_tr_b16 v[32:33], v16 offset:16640
ds_read_b64_tr_b16 v[34:35], v16 offset:16896
v_cmp_ne_u32 vcc, 1, v29
v_mfma_f32_16x16x32_bf16 v[132:135], v[36:39], a[120:123], v[132:135]
buffer_load_dwordx4 v18, s[16:19], s68 offen offset:0 lds
ds_read_b64_tr_b16 a[96:97], v10 offset:8192
v_mfma_f32_16x16x32_bf16 v[116:119], v[36:39], a[116:119], v[116:119]
s_cbranch_vccnz L_slow_p1
L_back_p1:
ds_read_b64_tr_b16 a[98:99], v10 offset:10240
ds_read_b64_tr_b16 a[100:101], v11 offset:8192
v_mfma_f32_16x16x32_bf16 v[100:103], v[36:39], a[112:115], v[100:103]
s_waitcnt lgkmcnt(7)
buffer_load_dwordx4 v19, s[16:19], s68 offen offset:1024 lds
ds_read_b64_tr_b16 a[102:103], v11 offset:10240
v_mfma_f32_16x16x32_bf16 v[104:107], v[40:43], a[112:115], v[104:107]
s_lshr_b32 s54, s35, 3
ds_read_b64_tr_b16 v[36:37], v16 offset:16672
ds_read_b64_tr_b16 v[38:39], v16 offset:16928
v_mfma_f32_16x16x32_bf16 v[120:123], v[40:43], a[116:119], v[120:123]
s_lshl_b32 s54, s54, 8
s_add_u32 s54, s54, 5120
s_lshl2_add_u32 s47, s32, s54
v_mfma_f32_16x16x32_bf16 v[136:139], v[40:43], a[120:123], v[136:139]
s_addk_i32 s54, 224
ds_read_b64_tr_b16 a[104:105], v12 offset:8192
ds_read_b64_tr_b16 a[106:107], v12 offset:10240
v_mfma_f32_16x16x32_bf16 v[152:155], v[40:43], a[124:127], v[152:155]
s_waitcnt lgkmcnt(10)
buffer_load_dwordx4 v20, s[16:19], s68 offen offset:2048 lds
ds_read_b64_tr_b16 a[108:109], v13 offset:8192
v_mfma_f32_16x16x32_bf16 v[156:159], v[44:47], a[124:127], v[156:159]
s_waitcnt lgkmcnt(10)
ds_read_b64_tr_b16 v[40:41], v16 offset:18720
ds_read_b64_tr_b16 v[42:43], v16 offset:18976
v_mfma_f32_16x16x32_bf16 v[140:143], v[44:47], a[120:123], v[140:143]
v_and_b32 v246, 60, v0
v_mul_u32_u24 v246, 3, v246
v_mfma_f32_16x16x32_bf16 v[124:127], v[44:47], a[116:119], v[124:127]
buffer_load_dword v29, v4, s[20:23], s50 offen sc1
v_add3_u32 v27, v246, v0, s47
v_mfma_f32_16x16x32_bf16 v[108:111], v[44:47], a[112:115], v[108:111]
s_waitcnt lgkmcnt(11)
buffer_load_dwordx4 v21, s[16:19], s68 offen offset:3072 lds
ds_read_b64_tr_b16 a[110:111], v13 offset:10240
v_mfma_f32_16x16x32_bf16 v[96:99], v[32:35], a[128:131], v[96:99]
s_waitcnt lgkmcnt(10)
ds_read_b64_tr_b16 v[44:45], v16 offset:18752
ds_read_b64_tr_b16 v[46:47], v16 offset:19008
v_mfma_f32_16x16x32_bf16 v[112:115], v[32:35], a[132:135], v[112:115]
v_subrev_u32 v246, 56, v0
v_ashrrev_i32 v246, 31, v246
v_mfma_f32_16x16x32_bf16 v[128:131], v[32:35], a[136:139], v[128:131]
s_add_u32 m0, s40, 148736
ds_read_b64_tr_b16 a[112:113], v10 offset:24576
ds_read_b64_tr_b16 a[114:115], v10 offset:26624
v_mfma_f32_16x16x32_bf16 v[144:147], v[32:35], a[140:143], v[144:147]
s_waitcnt lgkmcnt(10)
buffer_load_dwordx4 v245, s[20:23], s41 offen sc1 lds
ds_read_b64_tr_b16 a[116:117], v11 offset:24576
v_mfma_f32_16x16x32_bf16 v[148:151], v[36:39], a[140:143], v[148:151]
s_waitcnt lgkmcnt(10)
ds_read_b64_tr_b16 v[32:33], v16 offset:24960
ds_read_b64_tr_b16 v[34:35], v16 offset:25216
v_mfma_f32_16x16x32_bf16 v[132:135], v[36:39], a[136:139], v[132:135]
v_bfi_b32 v27, v246, v27, s54
v_lshlrev_b32 v27, 5, v27
v_mfma_f32_16x16x32_bf16 v[116:119], v[36:39], a[132:135], v[116:119]
s_waitcnt lgkmcnt(10)
ds_read_b64_tr_b16 a[118:119], v11 offset:26624
ds_read_b64_tr_b16 a[120:121], v12 offset:24576
v_mfma_f32_16x16x32_bf16 v[100:103], v[36:39], a[128:131], v[100:103]
s_waitcnt lgkmcnt(10)
buffer_load_dwordx4 v245, s[20:23], s41 offen offset:1024 sc1 lds
ds_read_b64_tr_b16 a[122:123], v12 offset:26624
v_mfma_f32_16x16x32_bf16 v[104:107], v[40:43], a[128:131], v[104:107]
ds_read_b64_tr_b16 v[36:37], v16 offset:24992
v_mfma_f32_16x16x32_bf16 v[120:123], v[40:43], a[132:135], v[120:123]
ds_read_b64_tr_b16 v[38:39], v16 offset:25248
v_mfma_f32_16x16x32_bf16 v[136:139], v[40:43], a[136:139], v[136:139]
ds_read_b64_tr_b16 a[124:125], v13 offset:24576
v_mfma_f32_16x16x32_bf16 v[152:155], v[40:43], a[140:143], v[152:155]
s_waitcnt lgkmcnt(11)
ds_read_b64_tr_b16 a[126:127], v13 offset:26624
v_mfma_f32_16x16x32_bf16 v[156:159], v[44:47], a[140:143], v[156:159]
ds_read_b64_tr_b16 v[40:41], v16 offset:27040
v_mfma_f32_16x16x32_bf16 v[140:143], v[44:47], a[136:139], v[140:143]
ds_read_b64_tr_b16 v[42:43], v16 offset:27296
v_mfma_f32_16x16x32_bf16 v[124:127], v[44:47], a[132:135], v[124:127]
v_mfma_f32_16x16x32_bf16 v[108:111], v[44:47], a[128:131], v[108:111]
s_waitcnt lgkmcnt(9)
v_mfma_f32_16x16x32_bf16 v[96:99], v[32:35], a[144:147], v[96:99]
ds_read_b64_tr_b16 v[44:45], v16 offset:27072
v_mfma_f32_16x16x32_bf16 v[112:115], v[32:35], a[148:151], v[112:115]
ds_read_b64_tr_b16 v[46:47], v16 offset:27328
v_mfma_f32_16x16x32_bf16 v[128:131], v[32:35], a[152:155], v[128:131]
v_mfma_f32_16x16x32_bf16 v[144:147], v[32:35], a[156:159], v[144:147]
s_waitcnt vmcnt(15) lgkmcnt(4)
s_barrier
v_mfma_f32_16x16x32_bf16 v[148:151], v[36:39], a[156:159], v[148:151]
ds_read_b64_tr_b16 v[32:33], v16 offset:33280
v_mfma_f32_16x16x32_bf16 v[132:135], v[36:39], a[152:155], v[132:135]
ds_read_b64_tr_b16 v[34:35], v16 offset:33536
v_mfma_f32_16x16x32_bf16 v[116:119], v[36:39], a[148:151], v[116:119]
ds_read_b64_tr_b16 a[128:129], v10 offset:12288
v_mfma_f32_16x16x32_bf16 v[100:103], v[36:39], a[144:147], v[100:103]
s_waitcnt lgkmcnt(5)
ds_read_b64_tr_b16 a[130:131], v10 offset:14336
v_mfma_f32_16x16x32_bf16 v[104:107], v[40:43], a[144:147], v[104:107]
ds_read_b64_tr_b16 v[36:37], v16 offset:33312
v_mfma_f32_16x16x32_bf16 v[120:123], v[40:43], a[148:151], v[120:123]
ds_read_b64_tr_b16 v[38:39], v16 offset:33568
v_mfma_f32_16x16x32_bf16 v[136:139], v[40:43], a[152:155], v[136:139]
ds_read_b64_tr_b16 a[132:133], v11 offset:12288
v_mfma_f32_16x16x32_bf16 v[152:155], v[40:43], a[156:159], v[152:155]
s_waitcnt lgkmcnt(7)
ds_read_b64_tr_b16 a[134:135], v11 offset:14336
v_mfma_f32_16x16x32_bf16 v[156:159], v[44:47], a[156:159], v[156:159]
ds_read_b64_tr_b16 v[40:41], v16 offset:35360
v_mfma_f32_16x16x32_bf16 v[140:143], v[44:47], a[152:155], v[140:143]
L_pad2:
s_cbranch_execz L_padret
ds_read_b64_tr_b16 v[42:43], v16 offset:35616
v_mfma_f32_16x16x32_bf16 v[124:127], v[44:47], a[148:151], v[124:127]
ds_read_b64_tr_b16 a[136:137], v12 offset:12288
v_mfma_f32_16x16x32_bf16 v[108:111], v[44:47], a[144:147], v[108:111]
s_waitcnt lgkmcnt(9)
ds_read_b64_tr_b16 a[138:139], v12 offset:14336
v_mfma_f32_16x16x32_bf16 v[96:99], v[32:35], a[160:163], v[96:99]
ds_read_b64_tr_b16 v[44:45], v16 offset:35392
v_mfma_f32_16x16x32_bf16 v[112:115], v[32:35], a[164:167], v[112:115]
ds_read_b64_tr_b16 v[46:47], v16 offset:35648
v_mfma_f32_16x16x32_bf16 v[128:131], v[32:35], a[168:171], v[128:131]
ds_read_b64_tr_b16 a[140:141], v13 offset:12288
v_mfma_f32_16x16x32_bf16 v[144:147], v[32:35], a[172:175], v[144:147]
s_waitcnt lgkmcnt(9)
ds_read_b64_tr_b16 a[142:143], v13 offset:14336
v_mfma_f32_16x16x32_bf16 v[148:151], v[36:39], a[172:175], v[148:151]
s_waitcnt vmcnt(3)
ds_read_b64_tr_b16 v[32:33], v16 offset:41600
ds_read_b64_tr_b16 v[34:35], v16 offset:41856
v_cmp_ne_u32 vcc, 1, v29
v_mfma_f32_16x16x32_bf16 v[132:135], v[36:39], a[168:171], v[132:135]
v_mfma_f32_16x16x32_bf16 v[116:119], v[36:39], a[164:167], v[116:119]
s_cbranch_vccnz L_slow_pA
L_back_pA:
ds_read_b64_tr_b16 a[144:145], v10 offset:28672
ds_read_b64_tr_b16 a[146:147], v10 offset:30720
v_mfma_f32_16x16x32_bf16 v[100:103], v[36:39], a[160:163], v[100:103]
s_waitcnt lgkmcnt(10)
buffer_load_dwordx4 v[160:163], v2, s[20:23], s4 offen offset:0 sc1
ds_read_b64_tr_b16 a[148:149], v11 offset:28672
v_mfma_f32_16x16x32_bf16 v[104:107], v[40:43], a[160:163], v[104:107]
ds_read_b64_tr_b16 v[36:37], v16 offset:41632
v_mfma_f32_16x16x32_bf16 v[120:123], v[40:43], a[164:167], v[120:123]
ds_read_b64_tr_b16 v[38:39], v16 offset:41888
buffer_load_dword v29, v31, s[20:23], 0 offen sc1
v_mfma_f32_16x16x32_bf16 v[136:139], v[40:43], a[168:171], v[136:139]
buffer_load_dwordx4 v[164:167], v2, s[20:23], s4 offen offset:1024 sc1
ds_read_b64_tr_b16 a[150:151], v11 offset:30720
v_mfma_f32_16x16x32_bf16 v[152:155], v[40:43], a[172:175], v[152:155]
s_waitcnt lgkmcnt(10)
ds_read_b64_tr_b16 a[152:153], v12 offset:28672
ds_read_b64_tr_b16 a[154:155], v12 offset:30720
v_mfma_f32_16x16x32_bf16 v[156:159], v[44:47], a[172:175], v[156:159]
s_waitcnt lgkmcnt(10)
ds_read_b64_tr_b16 v[40:41], v16 offset:43680
ds_read_b64_tr_b16 v[42:43], v16 offset:43936
v_mfma_f32_16x16x32_bf16 v[140:143], v[44:47], a[168:171], v[140:143]
buffer_load_dwordx4 v[168:171], v2, s[20:23], s5 offen offset:0 sc1
ds_read_b64_tr_b16 a[156:157], v13 offset:28672
v_mfma_f32_16x16x32_bf16 v[124:127], v[44:47], a[164:167], v[124:127]
ds_read_b64_tr_b16 a[158:159], v13 offset:30720
v_mfma_f32_16x16x32_bf16 v[108:111], v[44:47], a[160:163], v[108:111]
s_waitcnt lgkmcnt(12)
v_mfma_f32_16x16x32_bf16 v[96:99], v[32:35], a[176:179], v[96:99]
ds_read_b64_tr_b16 v[44:45], v16 offset:43712
v_mfma_f32_16x16x32_bf16 v[112:115], v[32:35], a[180:183], v[112:115]
ds_read_b64_tr_b16 v[46:47], v16 offset:43968
buffer_load_dwordx4 v[172:175], v2, s[20:23], s5 offen offset:1024 sc1
v_mfma_f32_16x16x32_bf16 v[128:131], v[32:35], a[184:187], v[128:131]
v_mfma_f32_16x16x32_bf16 v[144:147], v[32:35], a[188:191], v[144:147]
s_waitcnt vmcnt(5) lgkmcnt(2)
s_barrier
v_mfma_f32_16x16x32_bf16 v[148:151], v[36:39], a[188:191], v[148:151]
s_nop 0
ds_read_b64_tr_b16 v[32:33], v16 offset:49920
ds_read_b64_tr_b16 v[34:35], v16 offset:50176
v_mfma_f32_16x16x32_bf16 v[132:135], v[36:39], a[184:187], v[132:135]
buffer_load_dwordx4 v[176:179], v2, s[20:23], s6 offen offset:0 sc1
ds_read_b64_tr_b16 a[160:161], v10 offset:0
v_mfma_f32_16x16x32_bf16 v[116:119], v[36:39], a[180:183], v[116:119]
s_nop 0
ds_read_b64_tr_b16 a[162:163], v10 offset:2048
ds_read_b64_tr_b16 a[164:165], v11 offset:0
v_mfma_f32_16x16x32_bf16 v[100:103], v[36:39], a[176:179], v[100:103]
s_nop 0
ds_read_b64_tr_b16 v[80:81], v240 offset:0
ds_read_b64_tr_b16 v[82:83], v240 offset:2048
v_mfma_f32_16x16x32_bf16 v[104:107], v[40:43], a[176:179], v[104:107]
s_nop 0
ds_read_b64_tr_b16 v[36:37], v16 offset:49952
ds_read_b64_tr_b16 v[38:39], v16 offset:50208
v_mfma_f32_16x16x32_bf16 v[120:123], v[40:43], a[180:183], v[120:123]
buffer_load_dwordx4 v[180:183], v2, s[20:23], s6 offen offset:1024 sc1
ds_read_b64_tr_b16 a[166:167], v11 offset:2048
v_mfma_f32_16x16x32_bf16 v[136:139], v[40:43], a[184:187], v[136:139]
s_waitcnt lgkmcnt(10)
ds_read_b64_tr_b16 a[168:169], v12 offset:0
ds_read_b64_tr_b16 a[170:171], v12 offset:2048
v_mfma_f32_16x16x32_bf16 v[152:155], v[40:43], a[188:191], v[152:155]
s_waitcnt lgkmcnt(10)
ds_read_b64_tr_b16 v[84:85], v242 offset:0
ds_read_b64_tr_b16 v[86:87], v242 offset:2048
v_mfma_f32_16x16x32_bf16 v[156:159], v[44:47], a[188:191], v[156:159]
s_waitcnt lgkmcnt(10)
ds_read_b64_tr_b16 v[40:41], v16 offset:52000
ds_read_b64_tr_b16 v[42:43], v16 offset:52256
v_mfma_f32_16x16x32_bf16 v[140:143], v[44:47], a[184:187], v[140:143]
buffer_load_dwordx4 v[184:187], v2, s[20:23], s7 offen offset:0 sc1
ds_read_b64_tr_b16 a[172:173], v13 offset:0
v_mfma_f32_16x16x32_bf16 v[124:127], v[44:47], a[180:183], v[124:127]
s_waitcnt lgkmcnt(10)
ds_read_b64_tr_b16 a[174:175], v13 offset:2048
ds_read_b64_tr_b16 v[88:89], v241 offset:0
v_mfma_f32_16x16x32_bf16 v[108:111], v[44:47], a[176:179], v[108:111]
s_waitcnt lgkmcnt(10)
ds_read_b64_tr_b16 v[90:91], v241 offset:2048
ds_read_b64_tr_b16 v[92:93], v243 offset:0
v_mfma_f32_16x16x32_bf16 v[96:99], v[32:35], a[192:195], v[96:99]
s_waitcnt lgkmcnt(10)
ds_read_b64_tr_b16 v[44:45], v16 offset:52032
ds_read_b64_tr_b16 v[46:47], v16 offset:52288
v_mfma_f32_16x16x32_bf16 v[112:115], v[32:35], a[196:199], v[112:115]
buffer_load_dwordx4 v[188:191], v2, s[20:23], s7 offen offset:1024 sc1
ds_read_b64_tr_b16 a[176:177], v10 offset:16384
v_mfma_f32_16x16x32_bf16 v[128:131], v[32:35], a[200:203], v[128:131]
s_waitcnt lgkmcnt(10)
ds_read_b64_tr_b16 a[178:179], v10 offset:18432
ds_read_b64_tr_b16 a[180:181], v11 offset:16384
v_mfma_f32_16x16x32_bf16 v[144:147], v[32:35], a[204:207], v[144:147]
s_waitcnt lgkmcnt(10)
ds_read_b64_tr_b16 v[94:95], v243 offset:2048
ds_read_b64_tr_b16 v[208:209], v240 offset:4096
v_mfma_f32_16x16x32_bf16 v[148:151], v[36:39], a[204:207], v[148:151]
s_waitcnt lgkmcnt(10)
ds_read_b64_tr_b16 v[32:33], v16 offset:58240
ds_read_b64_tr_b16 v[34:35], v16 offset:58496
v_mfma_f32_16x16x32_bf16 v[132:135], v[36:39], a[200:203], v[132:135]
buffer_load_dwordx4 v[192:195], v2, s[20:23], s28 offen offset:0 sc1
ds_read_b64_tr_b16 a[182:183], v11 offset:18432
v_mfma_f32_16x16x32_bf16 v[116:119], v[36:39], a[196:199], v[116:119]
s_waitcnt lgkmcnt(10)
ds_read_b64_tr_b16 a[184:185], v12 offset:16384
ds_read_b64_tr_b16 a[186:187], v12 offset:18432
v_mfma_f32_16x16x32_bf16 v[100:103], v[36:39], a[192:195], v[100:103]
s_waitcnt lgkmcnt(10)
ds_read_b64_tr_b16 v[210:211], v240 offset:6144
ds_read_b64_tr_b16 v[212:213], v242 offset:4096
v_mfma_f32_16x16x32_bf16 v[104:107], v[40:43], a[192:195], v[104:107]
s_add_u32 s69, s69, 114688
ds_read_b64_tr_b16 v[36:37], v16 offset:58272
ds_read_b64_tr_b16 v[38:39], v16 offset:58528
v_mfma_f32_16x16x32_bf16 v[120:123], v[40:43], a[196:199], v[120:123]
s_add_u32 s3, s3, 114688
buffer_load_dwordx4 v[196:199], v2, s[20:23], s28 offen offset:1024 sc1
ds_read_b64_tr_b16 a[188:189], v13 offset:16384
v_mfma_f32_16x16x32_bf16 v[136:139], v[40:43], a[200:203], v[136:139]
s_waitcnt lgkmcnt(10)
ds_read_b64_tr_b16 a[190:191], v13 offset:18432
ds_read_b64_tr_b16 v[214:215], v242 offset:6144
v_mfma_f32_16x16x32_bf16 v[152:155], v[40:43], a[204:207], v[152:155]
s_waitcnt lgkmcnt(10)
ds_read_b64_tr_b16 v[216:217], v241 offset:4096
ds_read_b64_tr_b16 v[218:219], v241 offset:6144
v_mfma_f32_16x16x32_bf16 v[156:159], v[44:47], a[204:207], v[156:159]
s_waitcnt lgkmcnt(10)
ds_read_b64_tr_b16 v[40:41], v16 offset:60320
ds_read_b64_tr_b16 v[42:43], v16 offset:60576
v_mfma_f32_16x16x32_bf16 v[140:143], v[44:47], a[200:203], v[140:143]
buffer_load_dwordx4 v[200:203], v3, s[20:23], s4 offen offset:0 sc1
ds_read_b64_tr_b16 v[220:221], v243 offset:4096
v_mfma_f32_16x16x32_bf16 v[124:127], v[44:47], a[196:199], v[124:127]
ds_read_b64_tr_b16 v[222:223], v243 offset:6144
v_mfma_f32_16x16x32_bf16 v[108:111], v[44:47], a[192:195], v[108:111]
v_mfma_f32_16x16x32_bf16 v[96:99], v[32:35], a[208:211], v[96:99]
s_waitcnt vmcnt(10)
ds_read_b64_tr_b16 v[44:45], v16 offset:60352
s_waitcnt lgkmcnt(10)
ds_read_b64_tr_b16 v[46:47], v16 offset:60608
v_cmp_ne_u32 vcc, 1, v29
v_mfma_f32_16x16x32_bf16 v[112:115], v[32:35], a[212:215], v[112:115]
buffer_load_dwordx4 v[204:207], v3, s[20:23], s4 offen offset:1024 sc1
ds_read_b64_tr_b16 a[192:193], v10 offset:4096
v_mfma_f32_16x16x32_bf16 v[128:131], v[32:35], a[216:219], v[128:131]
s_cbranch_vccnz L_slow_pW
L_back_pW:
ds_read_b64_tr_b16 a[194:195], v10 offset:6144
ds_read_b64_tr_b16 a[196:197], v11 offset:4096
v_mfma_f32_16x16x32_bf16 v[144:147], v[32:35], a[220:223], v[144:147]
v_mfma_f32_16x16x32_bf16 v[148:151], v[36:39], a[220:223], v[148:151]
v_mfma_f32_16x16x32_bf16 v[132:135], v[36:39], a[216:219], v[132:135]
buffer_load_dwordx4 v[232:235], v1, s[20:23], s42 offen sc1
ds_read_b64_tr_b16 a[198:199], v11 offset:6144
v_mfma_f32_16x16x32_bf16 v[116:119], v[36:39], a[212:215], v[116:119]
s_waitcnt lgkmcnt(10)
ds_read_b64_tr_b16 a[200:201], v12 offset:4096
v_mfma_f32_16x16x32_bf16 v[100:103], v[36:39], a[208:211], v[100:103]
s_waitcnt lgkmcnt(9)
ds_read_b64_tr_b16 a[202:203], v12 offset:6144
v_mfma_f32_16x16x32_bf16 v[104:107], v[40:43], a[208:211], v[104:107]
v_mfma_f32_16x16x32_bf16 v[120:123], v[40:43], a[212:215], v[120:123]
s_add_u32 s42, s42, 4096
buffer_load_dwordx4 v[236:239], v1, s[20:23], s42 offen sc1
ds_read_b64_tr_b16 a[204:205], v13 offset:4096
v_mfma_f32_16x16x32_bf16 v[136:139], v[40:43], a[216:219], v[136:139]
ds_read_b64_tr_b16 a[206:207], v13 offset:6144
v_mfma_f32_16x16x32_bf16 v[152:155], v[40:43], a[220:223], v[152:155]
s_waitcnt lgkmcnt(8)
v_mfma_f32_16x16x32_bf16 v[156:159], v[44:47], a[220:223], v[156:159]
v_mfma_f32_16x16x32_bf16 v[140:143], v[44:47], a[216:219], v[140:143]
v_mfma_f32_16x16x32_bf16 v[124:127], v[44:47], a[212:215], v[124:127]
v_mfma_f32_16x16x32_bf16 v[108:111], v[44:47], a[208:211], v[108:111]
ds_read_b64_tr_b16 a[208:209], v10 offset:20480
ds_read_b64_tr_b16 a[210:211], v10 offset:22528
ds_read_b64_tr_b16 a[212:213], v11 offset:20480
ds_read_b64_tr_b16 a[214:215], v11 offset:22528
ds_read_b64_tr_b16 a[216:217], v12 offset:20480
ds_read_b64_tr_b16 a[218:219], v12 offset:22528
ds_read_b64_tr_b16 a[220:221], v13 offset:20480
s_waitcnt lgkmcnt(10)
ds_read_b64_tr_b16 a[222:223], v13 offset:22528
v_pk_mul_f32 v[248:249], v[96:97], s[44:45]
v_pk_mul_f32 v[250:251], v[98:99], s[44:45]
v_pk_mul_f32 v[252:253], v[100:101], s[44:45]
v_pk_mul_f32 v[254:255], v[102:103], s[44:45]
v_exp_f32 v248, v248
v_exp_f32 v249, v249
v_exp_f32 v250, v250
v_exp_f32 v251, v251
v_exp_f32 v252, v252
v_exp_f32 v253, v253
v_exp_f32 v254, v254
v_exp_f32 v255, v255
v_pk_mul_f32 v[104:105], v[96:97], v[104:105]
v_pk_mul_f32 v[106:107], v[98:99], v[106:107]
v_pk_mul_f32 v[108:109], v[100:101], v[108:109]
v_pk_mul_f32 v[110:111], v[102:103], v[110:111]
v_pk_add_f32 v[248:249], v[248:249], 1.0 op_sel_hi:[1,0]
v_pk_add_f32 v[250:251], v[250:251], 1.0 op_sel_hi:[1,0]
v_pk_add_f32 v[252:253], v[252:253], 1.0 op_sel_hi:[1,0]
v_pk_add_f32 v[254:255], v[254:255], 1.0 op_sel_hi:[1,0]
v_rcp_f32 v248, v248
v_rcp_f32 v249, v249
v_rcp_f32 v250, v250
v_rcp_f32 v251, v251
v_rcp_f32 v252, v252
v_rcp_f32 v253, v253
v_rcp_f32 v254, v254
v_rcp_f32 v255, v255
v_pk_mul_f32 v[104:105], v[104:105], v[248:249]
v_pk_mul_f32 v[106:107], v[106:107], v[250:251]
v_pk_mul_f32 v[108:109], v[108:109], v[252:253]
v_pk_mul_f32 v[110:111], v[110:111], v[254:255]
v_cvt_pk_bf16_f32 v96, v104, v105
v_cvt_pk_bf16_f32 v97, v106, v107
v_cvt_pk_bf16_f32 v98, v108, v109
v_cvt_pk_bf16_f32 v99, v110, v111
buffer_store_dwordx4 v[96:99], v1, s[20:23], s69 offen offset:0 sc1
v_pk_mul_f32 v[248:249], v[112:113], s[44:45]
v_pk_mul_f32 v[250:251], v[114:115], s[44:45]
v_pk_mul_f32 v[252:253], v[116:117], s[44:45]
v_pk_mul_f32 v[254:255], v[118:119], s[44:45]
v_exp_f32 v248, v248
v_exp_f32 v249, v249
v_exp_f32 v250, v250
v_exp_f32 v251, v251
v_exp_f32 v252, v252
v_exp_f32 v253, v253
v_exp_f32 v254, v254
v_exp_f32 v255, v255
v_pk_mul_f32 v[120:121], v[112:113], v[120:121]
v_pk_mul_f32 v[122:123], v[114:115], v[122:123]
v_pk_mul_f32 v[124:125], v[116:117], v[124:125]
v_pk_mul_f32 v[126:127], v[118:119], v[126:127]
v_pk_add_f32 v[248:249], v[248:249], 1.0 op_sel_hi:[1,0]
v_pk_add_f32 v[250:251], v[250:251], 1.0 op_sel_hi:[1,0]
v_pk_add_f32 v[252:253], v[252:253], 1.0 op_sel_hi:[1,0]
v_pk_add_f32 v[254:255], v[254:255], 1.0 op_sel_hi:[1,0]
v_rcp_f32 v248, v248
v_rcp_f32 v249, v249
v_rcp_f32 v250, v250
v_rcp_f32 v251, v251
v_rcp_f32 v252, v252
v_rcp_f32 v253, v253
v_rcp_f32 v254, v254
v_rcp_f32 v255, v255
v_pk_mul_f32 v[120:121], v[120:121], v[248:249]
v_pk_mul_f32 v[122:123], v[122:123], v[250:251]
v_pk_mul_f32 v[124:125], v[124:125], v[252:253]
v_pk_mul_f32 v[126:127], v[126:127], v[254:255]
v_cvt_pk_bf16_f32 v112, v120, v121
v_cvt_pk_bf16_f32 v113, v122, v123
v_cvt_pk_bf16_f32 v114, v124, v125
v_cvt_pk_bf16_f32 v115, v126, v127
buffer_store_dwordx4 v[112:115], v1, s[20:23], s69 offen offset:1024 sc1
v_pk_mul_f32 v[248:249], v[128:129], s[44:45]
v_pk_mul_f32 v[250:251], v[130:131], s[44:45]
v_pk_mul_f32 v[252:253], v[132:133], s[44:45]
v_pk_mul_f32 v[254:255], v[134:135], s[44:45]
v_exp_f32 v248, v248
v_exp_f32 v249, v249
v_exp_f32 v250, v250
v_exp_f32 v251, v251
v_exp_f32 v252, v252
v_exp_f32 v253, v253
v_exp_f32 v254, v254
v_exp_f32 v255, v255
v_pk_mul_f32 v[136:137], v[128:129], v[136:137]
v_pk_mul_f32 v[138:139], v[130:131], v[138:139]
v_pk_mul_f32 v[140:141], v[132:133], v[140:141]
v_pk_mul_f32 v[142:143], v[134:135], v[142:143]
v_pk_add_f32 v[248:249], v[248:249], 1.0 op_sel_hi:[1,0]
v_pk_add_f32 v[250:251], v[250:251], 1.0 op_sel_hi:[1,0]
v_pk_add_f32 v[252:253], v[252:253], 1.0 op_sel_hi:[1,0]
v_pk_add_f32 v[254:255], v[254:255], 1.0 op_sel_hi:[1,0]
v_rcp_f32 v248, v248
v_rcp_f32 v249, v249
v_rcp_f32 v250, v250
v_rcp_f32 v251, v251
v_rcp_f32 v252, v252
v_rcp_f32 v253, v253
v_rcp_f32 v254, v254
v_rcp_f32 v255, v255
v_pk_mul_f32 v[136:137], v[136:137], v[248:249]
v_pk_mul_f32 v[138:139], v[138:139], v[250:251]
v_pk_mul_f32 v[140:141], v[140:141], v[252:253]
v_pk_mul_f32 v[142:143], v[142:143], v[254:255]
v_cvt_pk_bf16_f32 v128, v136, v137
v_cvt_pk_bf16_f32 v129, v138, v139
v_cvt_pk_bf16_f32 v130, v140, v141
v_cvt_pk_bf16_f32 v131, v142, v143
buffer_store_dwordx4 v[128:131], v1, s[20:23], s3 offen offset:0 sc1
v_pk_mul_f32 v[248:249], v[144:145], s[44:45]
v_pk_mul_f32 v[250:251], v[146:147], s[44:45]
v_pk_mul_f32 v[252:253], v[148:149], s[44:45]
v_pk_mul_f32 v[254:255], v[150:151], s[44:45]
v_exp_f32 v248, v248
v_exp_f32 v249, v249
v_exp_f32 v250, v250
v_exp_f32 v251, v251
v_exp_f32 v252, v252
v_exp_f32 v253, v253
v_exp_f32 v254, v254
v_exp_f32 v255, v255
v_pk_mul_f32 v[152:153], v[144:145], v[152:153]
v_pk_mul_f32 v[154:155], v[146:147], v[154:155]
v_pk_mul_f32 v[156:157], v[148:149], v[156:157]
v_pk_mul_f32 v[158:159], v[150:151], v[158:159]
v_pk_add_f32 v[248:249], v[248:249], 1.0 op_sel_hi:[1,0]
v_pk_add_f32 v[250:251], v[250:251], 1.0 op_sel_hi:[1,0]
v_pk_add_f32 v[252:253], v[252:253], 1.0 op_sel_hi:[1,0]
v_pk_add_f32 v[254:255], v[254:255], 1.0 op_sel_hi:[1,0]
v_rcp_f32 v248, v248
v_rcp_f32 v249, v249
v_rcp_f32 v250, v250
v_rcp_f32 v251, v251
v_rcp_f32 v252, v252
v_rcp_f32 v253, v253
v_rcp_f32 v254, v254
v_rcp_f32 v255, v255
v_pk_mul_f32 v[152:153], v[152:153], v[248:249]
v_pk_mul_f32 v[154:155], v[154:155], v[250:251]
v_pk_mul_f32 v[156:157], v[156:157], v[252:253]
v_pk_mul_f32 v[158:159], v[158:159], v[254:255]
v_cvt_pk_bf16_f32 v144, v152, v153
v_cvt_pk_bf16_f32 v145, v154, v155
v_cvt_pk_bf16_f32 v146, v156, v157
v_cvt_pk_bf16_f32 v147, v158, v159
buffer_store_dwordx4 v[144:147], v1, s[20:23], s3 offen offset:1024 sc1
v_mfma_f32_16x16x32_bf16 v[96:99], v[80:83], a[224:227], 0
v_mfma_f32_16x16x32_bf16 v[104:107], v[80:83], a[240:243], 0
v_mfma_f32_16x16x32_bf16 v[100:103], v[84:87], a[224:227], 0
v_mfma_f32_16x16x32_bf16 v[108:111], v[84:87], a[240:243], 0
v_mfma_f32_16x16x32_bf16 v[96:99], v[88:91], a[232:235], v[96:99]
v_mfma_f32_16x16x32_bf16 v[104:107], v[88:91], a[224:227], v[104:107]
v_mfma_f32_16x16x32_bf16 v[100:103], v[92:95], a[232:235], v[100:103]
v_mfma_f32_16x16x32_bf16 v[108:111], v[92:95], a[224:227], v[108:111]
v_mfma_f32_16x16x32_bf16 v[96:99], v[208:211], a[228:231], v[96:99]
v_mfma_f32_16x16x32_bf16 v[104:107], v[208:211], a[244:247], v[104:107]
v_mfma_f32_16x16x32_bf16 v[100:103], v[212:215], a[228:231], v[100:103]
v_mfma_f32_16x16x32_bf16 v[108:111], v[212:215], a[244:247], v[108:111]
v_mfma_f32_16x16x32_bf16 v[96:99], v[216:219], a[236:239], v[96:99]
v_mfma_f32_16x16x32_bf16 v[104:107], v[216:219], a[228:231], v[104:107]
v_mfma_f32_16x16x32_bf16 v[100:103], v[220:223], a[236:239], v[100:103]
v_mfma_f32_16x16x32_bf16 v[108:111], v[220:223], a[228:231], v[108:111]
s_waitcnt vmcnt(4)
v_lshlrev_b32 v32, 16, v232
v_and_b32 v33, 0xffff0000, v232
v_lshlrev_b32 v34, 16, v233
v_and_b32 v35, 0xffff0000, v233
v_lshlrev_b32 v36, 16, v234
v_and_b32 v37, 0xffff0000, v234
v_lshlrev_b32 v38, 16, v235
v_and_b32 v39, 0xffff0000, v235
v_pk_mul_f32 v[120:121], v[96:97], v[56:57]
v_pk_mul_f32 v[112:113], v[104:105], v[56:57]
v_pk_mul_f32 v[122:123], v[98:99], v[58:59]
v_pk_mul_f32 v[114:115], v[106:107], v[58:59]
v_pk_mul_f32 v[124:125], v[100:101], v[60:61]
v_pk_mul_f32 v[116:117], v[108:109], v[60:61]
v_pk_mul_f32 v[126:127], v[102:103], v[62:63]
v_pk_mul_f32 v[118:119], v[110:111], v[62:63]
v_pk_fma_f32 v[112:113], v[96:97], v[48:49], v[112:113]
v_pk_fma_f32 v[120:121], v[104:105], v[48:49], v[120:121] neg_lo:[0,0,1] neg_hi:[0,0,1]
v_pk_fma_f32 v[114:115], v[98:99], v[50:51], v[114:115]
v_pk_fma_f32 v[122:123], v[106:107], v[50:51], v[122:123] neg_lo:[0,0,1] neg_hi:[0,0,1]
v_pk_fma_f32 v[116:117], v[100:101], v[52:53], v[116:117]
v_pk_fma_f32 v[124:125], v[108:109], v[52:53], v[124:125] neg_lo:[0,0,1] neg_hi:[0,0,1]
v_pk_fma_f32 v[118:119], v[102:103], v[54:55], v[118:119]
v_pk_fma_f32 v[126:127], v[110:111], v[54:55], v[126:127] neg_lo:[0,0,1] neg_hi:[0,0,1]
v_cvt_pk_bf16_f32 v80, v112, v113
v_cvt_pk_bf16_f32 v81, v114, v115
v_cvt_pk_bf16_f32 v82, v116, v117
v_cvt_pk_bf16_f32 v83, v118, v119
v_cvt_pk_bf16_f32 v84, v120, v121
v_cvt_pk_bf16_f32 v85, v122, v123
v_cvt_pk_bf16_f32 v86, v124, v125
v_cvt_pk_bf16_f32 v87, v126, v127
v_mfma_f32_16x16x32_bf16 v[96:99], a[248:251], v[80:83], 0
buffer_load_dwordx4 v[208:211], v2, s[20:23], s29 offen offset:0 sc1
v_xor_b32 v88, 0x80008000, v80
v_xor_b32 v89, 0x80008000, v81
v_mfma_f32_16x16x32_bf16 v[100:103], a[252:255], v[80:83], 0
v_xor_b32 v90, 0x80008000, v82
v_xor_b32 v91, 0x80008000, v83
v_mfma_f32_16x16x32_bf16 v[104:107], a[248:251], v[84:87], 0
buffer_load_dwordx4 v[212:215], v2, s[20:23], s29 offen offset:1024 sc1
v_mfma_f32_16x16x32_bf16 v[108:111], a[252:255], v[84:87], 0
v_mfma_f32_16x16x32_bf16 v[96:99], v[224:227], v[84:87], v[96:99]
v_mfma_f32_16x16x32_bf16 v[100:103], v[228:231], v[84:87], v[100:103]
buffer_load_dwordx4 v[216:219], v2, s[20:23], s30 offen offset:0 sc1
v_mfma_f32_16x16x32_bf16 v[104:107], v[224:227], v[88:91], v[104:107]
v_mfma_f32_16x16x32_bf16 v[108:111], v[228:231], v[88:91], v[108:111]
v_lshlrev_b32 v40, 16, v236
v_and_b32 v41, 0xffff0000, v236
v_lshlrev_b32 v42, 16, v237
v_and_b32 v43, 0xffff0000, v237
v_lshlrev_b32 v44, 16, v238
v_and_b32 v45, 0xffff0000, v238
v_lshlrev_b32 v46, 16, v239
v_and_b32 v47, 0xffff0000, v239
v_pk_mul_f32 v[120:121], v[96:97], v[40:41]
v_pk_mul_f32 v[112:113], v[104:105], v[40:41]
v_pk_mul_f32 v[122:123], v[98:99], v[42:43]
v_pk_mul_f32 v[114:115], v[106:107], v[42:43]
v_pk_mul_f32 v[124:125], v[100:101], v[44:45]
v_pk_mul_f32 v[116:117], v[108:109], v[44:45]
v_pk_mul_f32 v[126:127], v[102:103], v[46:47]
v_pk_mul_f32 v[118:119], v[110:111], v[46:47]
v_pk_fma_f32 v[112:113], v[96:97], v[32:33], v[112:113] neg_lo:[0,0,1] neg_hi:[0,0,1]
v_pk_fma_f32 v[120:121], v[104:105], v[32:33], v[120:121]
v_pk_fma_f32 v[114:115], v[98:99], v[34:35], v[114:115] neg_lo:[0,0,1] neg_hi:[0,0,1]
v_pk_fma_f32 v[122:123], v[106:107], v[34:35], v[122:123]
v_pk_fma_f32 v[116:117], v[100:101], v[36:37], v[116:117] neg_lo:[0,0,1] neg_hi:[0,0,1]
v_pk_fma_f32 v[124:125], v[108:109], v[36:37], v[124:125]
v_pk_fma_f32 v[118:119], v[102:103], v[38:39], v[118:119] neg_lo:[0,0,1] neg_hi:[0,0,1]
v_pk_fma_f32 v[126:127], v[110:111], v[38:39], v[126:127]
v_cvt_pk_bf16_f32 v80, v112, v113
v_cvt_pk_bf16_f32 v81, v114, v115
v_cvt_pk_bf16_f32 v82, v116, v117
v_cvt_pk_bf16_f32 v83, v118, v119
v_cvt_pk_bf16_f32 v84, v120, v121
v_cvt_pk_bf16_f32 v85, v122, v123
v_cvt_pk_bf16_f32 v86, v124, v125
v_cvt_pk_bf16_f32 v87, v126, v127
v_mfma_f32_16x16x32_bf16 v[96:99], v[80:83], a[248:251], 0
buffer_load_dwordx4 v[220:223], v2, s[20:23], s30 offen offset:1024 sc1
v_xor_b32 v88, 0x80008000, v84
v_xor_b32 v89, 0x80008000, v85
v_mfma_f32_16x16x32_bf16 v[100:103], v[80:83], a[252:255], 0
v_xor_b32 v90, 0x80008000, v86
v_xor_b32 v91, 0x80008000, v87
v_mfma_f32_16x16x32_bf16 v[104:107], v[80:83], v[224:227], 0
buffer_load_dwordx4 v[48:51], v3, s[20:23], s5 offen offset:0 sc1
v_mfma_f32_16x16x32_bf16 v[108:111], v[80:83], v[228:231], 0
v_mfma_f32_16x16x32_bf16 v[96:99], v[88:91], v[224:227], v[96:99]
v_mfma_f32_16x16x32_bf16 v[100:103], v[88:91], v[228:231], v[100:103]
buffer_load_dwordx4 v[52:55], v3, s[20:23], s5 offen offset:1024 sc1
v_mfma_f32_16x16x32_bf16 v[104:107], v[84:87], a[248:251], v[104:107]
v_mfma_f32_16x16x32_bf16 v[108:111], v[84:87], a[252:255], v[108:111]
s_lshr_b32 s40, s32, 1
s_lshl_b32 s40, s40, 10
s_and_b32 s42, s32, 1
s_lshl3_add_u32 s40, s42, s40
v_add_u32 v240, s40, v1
v_pk_mul_f32 v[120:121], v[96:97], v[72:73]
s_nop 0
v_pk_mul_f32 v[112:113], v[104:105], v[72:73]
v_pk_mul_f32 v[122:123], v[98:99], v[74:75]
v_pk_mul_f32 v[114:115], v[106:107], v[74:75]
v_pk_mul_f32 v[124:125], v[100:101], v[76:77]
v_pk_mul_f32 v[116:117], v[108:109], v[76:77]
v_pk_mul_f32 v[126:127], v[102:103], v[78:79]
v_pk_mul_f32 v[118:119], v[110:111], v[78:79]
v_pk_fma_f32 v[112:113], v[96:97], v[64:65], v[112:113] neg_lo:[0,0,1] neg_hi:[0,0,1]
v_pk_fma_f32 v[120:121], v[104:105], v[64:65], v[120:121]
v_pk_fma_f32 v[114:115], v[98:99], v[66:67], v[114:115] neg_lo:[0,0,1] neg_hi:[0,0,1]
v_pk_fma_f32 v[122:123], v[106:107], v[66:67], v[122:123]
s_add_u32 s79, s79, 16384
s_waitcnt vmcnt(6)
buffer_store_dword v28, v30, s[20:23], s79 offen sc1
v_pk_fma_f32 v[116:117], v[100:101], v[68:69], v[116:117] neg_lo:[0,0,1] neg_hi:[0,0,1]
v_pk_fma_f32 v[124:125], v[108:109], v[68:69], v[124:125]
v_pk_fma_f32 v[118:119], v[102:103], v[70:71], v[118:119] neg_lo:[0,0,1] neg_hi:[0,0,1]
v_pk_fma_f32 v[126:127], v[110:111], v[70:71], v[126:127]
v_cvt_pk_bf16_f32 v80, v112, v113
v_cvt_pk_bf16_f32 v81, v114, v115
v_cvt_pk_bf16_f32 v82, v116, v117
v_cvt_pk_bf16_f32 v83, v118, v119
v_cvt_pk_bf16_f32 v84, v120, v121
v_cvt_pk_bf16_f32 v85, v122, v123
v_cvt_pk_bf16_f32 v86, v124, v125
v_cvt_pk_bf16_f32 v87, v126, v127
ds_write_b64 v240, v[80:81] offset:8192
ds_write_b64 v240, v[82:83] offset:10240
ds_write_b64 v240, v[84:85] offset:12288
ds_write_b64 v240, v[86:87] offset:14336
s_waitcnt lgkmcnt(0)
s_barrier
ds_read_b128 v[128:131], v1 offset:8192
ds_read_b128 v[136:139], v1 offset:10240
ds_read_b128 v[144:147], v1 offset:12288
ds_read_b128 v[152:155], v1 offset:14336
ds_read_b128 v[132:135], v1 offset:9216
ds_read_b128 v[140:143], v1 offset:11264
ds_read_b128 v[148:151], v1 offset:13312
ds_read_b128 v[156:159], v1 offset:15360
s_waitcnt lgkmcnt(7)
v_mfma_f32_16x16x32_bf16 v[96:99], v[128:131], a[224:227], 0
buffer_load_dwordx4 v[56:59], v3, s[20:23], s6 offen offset:0 sc1
v_mfma_f32_16x16x32_bf16 v[104:107], v[128:131], a[232:235], 0
s_waitcnt lgkmcnt(6)
v_mfma_f32_16x16x32_bf16 v[100:103], v[136:139], a[224:227], 0
buffer_load_dwordx4 v[60:63], v3, s[20:23], s6 offen offset:1024 sc1
v_mfma_f32_16x16x32_bf16 v[108:111], v[136:139], a[232:235], 0
s_waitcnt lgkmcnt(5)
v_mfma_f32_16x16x32_bf16 v[96:99], v[144:147], a[240:243], v[96:99]
v_mfma_f32_16x16x32_bf16 v[104:107], v[144:147], a[224:227], v[104:107]
s_waitcnt lgkmcnt(4)
v_mfma_f32_16x16x32_bf16 v[100:103], v[152:155], a[240:243], v[100:103]
buffer_load_dwordx4 v[64:67], v3, s[20:23], s7 offen offset:0 sc1
v_mfma_f32_16x16x32_bf16 v[108:111], v[152:155], a[224:227], v[108:111]
s_waitcnt lgkmcnt(3)
v_mfma_f32_16x16x32_bf16 v[96:99], v[132:135], a[228:231], v[96:99]
v_mfma_f32_16x16x32_bf16 v[104:107], v[132:135], a[236:239], v[104:107]
s_waitcnt lgkmcnt(2)
v_mfma_f32_16x16x32_bf16 v[100:103], v[140:143], a[228:231], v[100:103]
buffer_load_dwordx4 v[68:71], v3, s[20:23], s7 offen offset:1024 sc1
v_mfma_f32_16x16x32_bf16 v[108:111], v[140:143], a[236:239], v[108:111]
s_waitcnt lgkmcnt(1)
v_mfma_f32_16x16x32_bf16 v[96:99], v[148:151], a[244:247], v[96:99]
v_mfma_f32_16x16x32_bf16 v[104:107], v[148:151], a[228:231], v[104:107]
s_waitcnt lgkmcnt(0)
v_mfma_f32_16x16x32_bf16 v[100:103], v[156:159], a[244:247], v[100:103]
buffer_load_dwordx4 v[72:75], v3, s[20:23], s28 offen offset:0 sc1
v_mfma_f32_16x16x32_bf16 v[108:111], v[156:159], a[228:231], v[108:111]
s_nop 2
v_cvt_pk_bf16_f32 v80, v96, v97
v_cvt_pk_bf16_f32 v81, v98, v99
s_nop 0
v_cvt_pk_bf16_f32 v82, v100, v101
v_cvt_pk_bf16_f32 v83, v102, v103
buffer_store_dwordx4 v[80:83], v1, s[20:23], s48 offen sc1
v_cvt_pk_bf16_f32 v84, v104, v105
v_cvt_pk_bf16_f32 v85, v106, v107
v_cvt_pk_bf16_f32 v86, v108, v109
v_cvt_pk_bf16_f32 v87, v110, v111
buffer_store_dwordx4 v[84:87], v244, s[20:23], s48 offen sc1
v_mfma_f32_16x16x32_bf16 v[100:103], a[4:7], v[160:163], 0
s_lshl1_add_u32 s40, s49, s1
buffer_load_dwordx4 v[76:79], v3, s[20:23], s28 offen offset:1024 sc1
v_add_u32 v12, s53, v1
v_mfma_f32_16x16x32_bf16 v[96:99], a[0:3], v[160:163], 0
s_mov_b32 s42, 9586981
v_and_b32 v242, 15, v0
v_lshl_add_u32 v242, s40, 4, v242
v_mfma_f32_16x16x32_bf16 v[116:119], a[12:15], v[160:163], 0
v_mul_lo_u32 v247, v242, s42
v_lshrrev_b32 v243, 4, v0
v_mfma_f32_16x16x32_bf16 v[112:115], a[8:11], v[160:163], 0
buffer_load_dwordx4 v[32:35], v3, s[20:23], s29 offen offset:0 sc1
v_lshlrev_b32 v244, 1, v243
v_mfma_f32_16x16x32_bf16 v[120:123], a[8:11], v[164:167], 0
v_mul_lo_u32 v246, v244, v247
v_lshlrev_b32 v244, 3, v247
v_mfma_f32_16x16x32_bf16 v[124:127], a[12:15], v[164:167], 0
v_alignbit_b32 v245, s46, v244, 9
v_sub_u32 v244, v244, v247
v_mfma_f32_16x16x32_bf16 v[104:107], a[0:3], v[164:167], 0
buffer_load_dwordx4 v[36:39], v3, s[20:23], s29 offen offset:1024 sc1
v_mfma_f32_16x16x32_bf16 v[108:111], a[4:7], v[164:167], 0
v_cos_f32 v241, v245
v_mfma_f32_16x16x32_bf16 v[100:103], a[20:23], v[168:171], v[100:103]
L_pad3:
s_cbranch_execz L_padret
v_alignbit_b32 v245, s46, v246, 9
v_add_u32 v246, v246, v247
v_mfma_f32_16x16x32_bf16 v[96:99], a[16:19], v[168:171], v[96:99]
buffer_load_dwordx4 v[40:43], v3, s[20:23], s30 offen offset:0 sc1
v_add_f32 v241, v241, v241
v_mfma_f32_16x16x32_bf16 v[116:119], a[28:31], v[168:171], v[116:119]
v_cos_f32 v224, v245
v_mfma_f32_16x16x32_bf16 v[112:115], a[24:27], v[168:171], v[112:115]
v_sin_f32 v225, -v245
v_mfma_f32_16x16x32_bf16 v[120:123], a[24:27], v[172:175], v[120:123]
buffer_load_dwordx4 v[44:47], v3, s[20:23], s30 offen offset:1024 sc1
v_alignbit_b32 v245, s46, v246, 9
v_mfma_f32_16x16x32_bf16 v[124:127], a[28:31], v[172:175], v[124:127]
v_cos_f32 v226, v245
v_mfma_f32_16x16x32_bf16 v[104:107], a[16:19], v[172:175], v[104:107]
v_sin_f32 v227, -v245
v_mfma_f32_16x16x32_bf16 v[108:111], a[20:23], v[172:175], v[108:111]
v_add_u32 v246, v246, v244
v_alignbit_b32 v245, s46, v246, 9
v_mfma_f32_16x16x32_bf16 v[100:103], a[36:39], v[176:179], v[100:103]
v_cos_f32 v228, v245
v_mfma_f32_16x16x32_bf16 v[96:99], a[32:35], v[176:179], v[96:99]
v_sin_f32 v229, -v245
v_mfma_f32_16x16x32_bf16 v[116:119], a[44:47], v[176:179], v[116:119]
v_add_u32 v246, v246, v247
v_alignbit_b32 v245, s46, v246, 9
v_mfma_f32_16x16x32_bf16 v[112:115], a[40:43], v[176:179], v[112:115]
v_cos_f32 v230, v245
v_mfma_f32_16x16x32_bf16 v[120:123], a[40:43], v[180:183], v[120:123]
v_sin_f32 v231, -v245
v_mfma_f32_16x16x32_bf16 v[124:127], a[44:47], v[180:183], v[124:127]
v_fma_f32 v232, v241, v228, -v224
v_fma_f32 v233, v241, v229, -v225
v_mfma_f32_16x16x32_bf16 v[104:107], a[32:35], v[180:183], v[104:107]
v_fma_f32 v234, v241, v230, -v226
v_fma_f32 v235, v241, v231, -v227
v_mfma_f32_16x16x32_bf16 v[108:111], a[36:39], v[180:183], v[108:111]
v_fma_f32 v236, v241, v232, -v228
v_fma_f32 v237, v241, v233, -v229
v_mfma_f32_16x16x32_bf16 v[100:103], a[52:55], v[184:187], v[100:103]
v_fma_f32 v238, v241, v234, -v230
v_fma_f32 v239, v241, v235, -v231
v_mfma_f32_16x16x32_bf16 v[96:99], a[48:51], v[184:187], v[96:99]
v_fma_f32 v240, v241, v241, -2.0
v_sub_f32 v241, 0, v240
v_mfma_f32_16x16x32_bf16 v[116:119], a[60:63], v[184:187], v[116:119]
v_cvt_pk_bf16_f32 v80, v224, v225
v_cvt_pk_bf16_f32 v81, v226, v227
v_mfma_f32_16x16x32_bf16 v[112:115], a[56:59], v[184:187], v[112:115]
v_cvt_pk_bf16_f32 v82, v228, v229
v_cvt_pk_bf16_f32 v83, v230, v231
v_mfma_f32_16x16x32_bf16 v[120:123], a[56:59], v[188:191], v[120:123]
s_add_u32 s50, s50, 16384
s_load_dwordx8 s[56:63], s[20:21], s50 glc
s_load_dwordx8 s[64:71], s[20:21], s50 offset:512 glc
v_mfma_f32_16x16x32_bf16 v[124:127], a[60:63], v[188:191], v[124:127]
v_cvt_pk_bf16_f32 v84, v232, v233
v_cvt_pk_bf16_f32 v85, v234, v235
v_mfma_f32_16x16x32_bf16 v[104:107], a[48:51], v[188:191], v[104:107]
v_cvt_pk_bf16_f32 v86, v236, v237
v_cvt_pk_bf16_f32 v87, v238, v239
v_mfma_f32_16x16x32_bf16 v[108:111], a[52:55], v[188:191], v[108:111]
v_lshlrev_b32 v244, 31, v242
v_or_b32 v244, 0x3f803f80, v244
v_mfma_f32_16x16x32_bf16 v[100:103], a[68:71], v[192:195], v[100:103]
v_add_u32 v245, -1, v243
v_ashrrev_i32 v245, 31, v245
v_mfma_f32_16x16x32_bf16 v[96:99], a[64:67], v[192:195], v[96:99]
v_bfi_b32 v80, v245, v244, v80
v_lshl_add_u32 v10, s32, 10, v1
v_mfma_f32_16x16x32_bf16 v[116:119], a[76:79], v[192:195], v[116:119]
ds_write_b128 v25, v[80:83] offset:0
v_mfma_f32_16x16x32_bf16 v[112:115], a[72:75], v[192:195], v[112:115]
ds_write_b128 v25, v[84:87] offset:1024
v_mfma_f32_16x16x32_bf16 v[120:123], a[72:75], v[196:199], v[120:123]
v_fmac_f32 v224, v241, v232
v_fmac_f32 v225, v241, v233
v_mfma_f32_16x16x32_bf16 v[124:127], a[76:79], v[196:199], v[124:127]
v_fmac_f32 v226, v241, v234
v_fmac_f32 v227, v241, v235
v_mfma_f32_16x16x32_bf16 v[104:107], a[64:67], v[196:199], v[104:107]
v_fmac_f32 v228, v241, v236
v_fmac_f32 v229, v241, v237
v_mfma_f32_16x16x32_bf16 v[108:111], a[68:71], v[196:199], v[108:111]
s_waitcnt vmcnt(18)
v_fmac_f32 v230, v241, v238
v_fmac_f32 v231, v241, v239
v_mfma_f32_16x16x32_bf16 v[100:103], a[84:87], v[208:211], v[100:103]
v_cvt_pk_bf16_f32 v88, -v224, -v225
v_cvt_pk_bf16_f32 v89, -v226, -v227
v_mfma_f32_16x16x32_bf16 v[96:99], a[80:83], v[208:211], v[96:99]
v_cvt_pk_bf16_f32 v90, -v228, -v229
v_cvt_pk_bf16_f32 v91, -v230, -v231
v_mfma_f32_16x16x32_bf16 v[116:119], a[92:95], v[208:211], v[116:119]
ds_write_b128 v25, v[88:91] offset:2048
v_mfma_f32_16x16x32_bf16 v[112:115], a[88:91], v[208:211], v[112:115]
s_waitcnt vmcnt(17)
v_fmac_f32 v232, v240, v224
v_fmac_f32 v233, v240, v225
v_mfma_f32_16x16x32_bf16 v[120:123], a[88:91], v[212:215], v[120:123]
v_fmac_f32 v234, v240, v226
v_fmac_f32 v235, v240, v227
v_mfma_f32_16x16x32_bf16 v[124:127], a[92:95], v[212:215], v[124:127]
v_fmac_f32 v236, v240, v228
v_fmac_f32 v237, v240, v229
v_mfma_f32_16x16x32_bf16 v[104:107], a[80:83], v[212:215], v[104:107]
v_fmac_f32 v238, v240, v230
v_fmac_f32 v239, v240, v231
v_mfma_f32_16x16x32_bf16 v[108:111], a[84:87], v[212:215], v[108:111]
s_waitcnt vmcnt(16)
v_cvt_pk_bf16_f32 v92, -v232, -v233
v_cvt_pk_bf16_f32 v93, -v234, -v235
v_mfma_f32_16x16x32_bf16 v[100:103], a[100:103], v[216:219], v[100:103]
s_waitcnt vmcnt(5)
buffer_store_dword v28, v30, s[20:23], s51 offen sc1
v_cvt_pk_bf16_f32 v94, -v236, -v237
v_mfma_f32_16x16x32_bf16 v[96:99], a[96:99], v[216:219], v[96:99]
v_cvt_pk_bf16_f32 v95, -v238, -v239
v_fmac_f32 v224, v241, v232
v_mfma_f32_16x16x32_bf16 v[116:119], a[108:111], v[216:219], v[116:119]
ds_write_b128 v25, v[92:95] offset:3072
v_mfma_f32_16x16x32_bf16 v[112:115], a[104:107], v[216:219], v[112:115]
v_fmac_f32 v225, v241, v233
v_fmac_f32 v226, v241, v234
v_mfma_f32_16x16x32_bf16 v[120:123], a[104:107], v[220:223], v[120:123]
v_fmac_f32 v227, v241, v235
v_fmac_f32 v228, v241, v236
v_mfma_f32_16x16x32_bf16 v[124:127], a[108:111], v[220:223], v[124:127]
v_fmac_f32 v229, v241, v237
v_fmac_f32 v230, v241, v238
v_mfma_f32_16x16x32_bf16 v[104:107], a[96:99], v[220:223], v[104:107]
v_fmac_f32 v231, v241, v239
v_cvt_pk_bf16_f32 v248, v224, v225
v_mfma_f32_16x16x32_bf16 v[108:111], a[100:103], v[220:223], v[108:111]
v_cvt_pk_bf16_f32 v249, v226, v227
v_cvt_pk_bf16_f32 v250, v228, v229
v_mfma_f32_16x16x32_bf16 v[132:135], a[4:7], v[200:203], 0
v_cvt_pk_bf16_f32 v251, v230, v231
v_fmac_f32 v232, v240, v224
v_mfma_f32_16x16x32_bf16 v[128:131], a[0:3], v[200:203], 0
ds_write_b128 v25, v[248:251] offset:4096
v_mfma_f32_16x16x32_bf16 v[148:151], a[12:15], v[200:203], 0
v_fmac_f32 v233, v240, v225
v_fmac_f32 v234, v240, v226
v_mfma_f32_16x16x32_bf16 v[144:147], a[8:11], v[200:203], 0
v_fmac_f32 v235, v240, v227
v_fmac_f32 v236, v240, v228
v_mfma_f32_16x16x32_bf16 v[152:155], a[8:11], v[204:207], 0
v_fmac_f32 v237, v240, v229
v_fmac_f32 v238, v240, v230
v_mfma_f32_16x16x32_bf16 v[156:159], a[12:15], v[204:207], 0
v_fmac_f32 v239, v240, v231
v_cvt_pk_bf16_f32 v252, v232, v233
v_mfma_f32_16x16x32_bf16 v[136:139], a[0:3], v[204:207], 0
v_cvt_pk_bf16_f32 v253, v234, v235
v_cvt_pk_bf16_f32 v254, v236, v237
v_mfma_f32_16x16x32_bf16 v[140:143], a[4:7], v[204:207], 0
v_cvt_pk_bf16_f32 v255, v238, v239
v_fmac_f32 v224, v241, v232
v_mfma_f32_16x16x32_bf16 v[132:135], a[20:23], v[48:51], v[132:135]
ds_write_b128 v25, v[252:255] offset:5120
v_mfma_f32_16x16x32_bf16 v[128:131], a[16:19], v[48:51], v[128:131]
s_waitcnt lgkmcnt(0)
s_and_b64 s[56:57], s[56:57], s[58:59]
s_and_b64 s[56:57], s[56:57], s[60:61]
v_mfma_f32_16x16x32_bf16 v[148:151], a[28:31], v[48:51], v[148:151]
s_and_b64 s[56:57], s[56:57], s[64:65]
s_and_b64 s[56:57], s[56:57], s[66:67]
s_and_b64 s[56:57], s[56:57], s[68:69]
v_mfma_f32_16x16x32_bf16 v[144:147], a[24:27], v[48:51], v[144:147]
s_and_b32 s56, s56, s62
s_and_b32 s56, s56, s70
v_mfma_f32_16x16x32_bf16 v[152:155], a[24:27], v[52:55], v[152:155]
s_and_b32 s56, s56, s57
s_cbranch_scc0 L_slow_pB
L_back_pB:
v_fmac_f32 v225, v241, v233
v_mfma_f32_16x16x32_bf16 v[156:159], a[28:31], v[52:55], v[156:159]
s_add_u32 s73, s4, 114688
buffer_load_dwordx4 v[160:163], v2, s[20:23], s73 offen offset:0 sc1
v_fmac_f32 v226, v241, v234
v_mfma_f32_16x16x32_bf16 v[136:139], a[16:19], v[52:55], v[136:139]
buffer_load_dwordx4 v[164:167], v2, s[20:23], s73 offen offset:1024 sc1
v_fmac_f32 v227, v241, v235
v_mfma_f32_16x16x32_bf16 v[140:143], a[20:23], v[52:55], v[140:143]
v_fmac_f32 v228, v241, v236
v_fmac_f32 v229, v241, v237
v_mfma_f32_16x16x32_bf16 v[132:135], a[36:39], v[56:59], v[132:135]
v_fmac_f32 v230, v241, v238
v_fmac_f32 v231, v241, v239
v_mfma_f32_16x16x32_bf16 v[128:131], a[32:35], v[56:59], v[128:131]
s_add_u32 s73, s5, 114688
buffer_load_dwordx4 v[168:171], v2, s[20:23], s73 offen offset:0 sc1
v_cvt_pk_bf16_f32 v18, -v224, -v225
v_mfma_f32_16x16x32_bf16 v[148:151], a[44:47], v[56:59], v[148:151]
v_cvt_pk_bf16_f32 v19, -v226, -v227
v_cvt_pk_bf16_f32 v20, -v228, -v229
v_mfma_f32_16x16x32_bf16 v[144:147], a[40:43], v[56:59], v[144:147]
v_cvt_pk_bf16_f32 v21, -v230, -v231
v_mfma_f32_16x16x32_bf16 v[152:155], a[40:43], v[60:63], v[152:155]
buffer_load_dwordx4 v[172:175], v2, s[20:23], s73 offen offset:1024 sc1
v_mfma_f32_16x16x32_bf16 v[156:159], a[44:47], v[60:63], v[156:159]
ds_write_b128 v25, v[18:21] offset:6144
v_mfma_f32_16x16x32_bf16 v[136:139], a[32:35], v[60:63], v[136:139]
v_fmac_f32 v232, v240, v224
v_fmac_f32 v233, v240, v225
v_mfma_f32_16x16x32_bf16 v[140:143], a[36:39], v[60:63], v[140:143]
s_add_u32 s73, s6, 114688
buffer_load_dwordx4 v[176:179], v2, s[20:23], s73 offen offset:0 sc1
v_mfma_f32_16x16x32_bf16 v[132:135], a[52:55], v[64:67], v[132:135]
v_fmac_f32 v234, v240, v226
v_fmac_f32 v235, v240, v227
v_mfma_f32_16x16x32_bf16 v[128:131], a[48:51], v[64:67], v[128:131]
v_fmac_f32 v236, v240, v228
v_fmac_f32 v237, v240, v229
v_mfma_f32_16x16x32_bf16 v[148:151], a[60:63], v[64:67], v[148:151]
buffer_load_dwordx4 v[180:183], v2, s[20:23], s73 offen offset:1024 sc1
v_fmac_f32 v238, v240, v230
v_mfma_f32_16x16x32_bf16 v[144:147], a[56:59], v[64:67], v[144:147]
v_fmac_f32 v239, v240, v231
v_cvt_pk_bf16_f32 v48, -v232, -v233
v_mfma_f32_16x16x32_bf16 v[152:155], a[56:59], v[68:71], v[152:155]
v_cvt_pk_bf16_f32 v49, -v234, -v235
v_cvt_pk_bf16_f32 v50, -v236, -v237
v_mfma_f32_16x16x32_bf16 v[156:159], a[60:63], v[68:71], v[156:159]
s_add_u32 s73, s7, 114688
buffer_load_dwordx4 v[184:187], v2, s[20:23], s73 offen offset:0 sc1
v_cvt_pk_bf16_f32 v51, -v238, -v239
v_mfma_f32_16x16x32_bf16 v[136:139], a[48:51], v[68:71], v[136:139]
ds_write_b128 v25, v[48:51] offset:7168
v_mfma_f32_16x16x32_bf16 v[140:143], a[52:55], v[68:71], v[140:143]
v_fmac_f32 v224, v241, v232
v_fmac_f32 v225, v241, v233
v_mfma_f32_16x16x32_bf16 v[132:135], a[68:71], v[72:75], v[132:135]
buffer_load_dwordx4 v[188:191], v2, s[20:23], s73 offen offset:1024 sc1
v_fmac_f32 v226, v241, v234
v_mfma_f32_16x16x32_bf16 v[128:131], a[64:67], v[72:75], v[128:131]
v_fmac_f32 v227, v241, v235
v_fmac_f32 v228, v241, v236
v_mfma_f32_16x16x32_bf16 v[148:151], a[76:79], v[72:75], v[148:151]
v_fmac_f32 v229, v241, v237
v_fmac_f32 v230, v241, v238
v_mfma_f32_16x16x32_bf16 v[144:147], a[72:75], v[72:75], v[144:147]
s_waitcnt vmcnt(13)
s_add_u32 s73, s28, 114688
buffer_load_dwordx4 v[192:195], v2, s[20:23], s73 offen offset:0 sc1
v_mfma_f32_16x16x32_bf16 v[152:155], a[72:75], v[76:79], v[152:155]
v_fmac_f32 v231, v241, v239
v_cvt_pk_bf16_f32 v52, v224, v225
v_mfma_f32_16x16x32_bf16 v[156:159], a[76:79], v[76:79], v[156:159]
v_cvt_pk_bf16_f32 v53, v226, v227
v_cvt_pk_bf16_f32 v54, v228, v229
v_mfma_f32_16x16x32_bf16 v[136:139], a[64:67], v[76:79], v[136:139]
buffer_load_dwordx4 v[196:199], v2, s[20:23], s73 offen offset:1024 sc1
v_cvt_pk_bf16_f32 v55, v230, v231
v_mfma_f32_16x16x32_bf16 v[140:143], a[68:71], v[76:79], v[140:143]
s_waitcnt vmcnt(14)
ds_write_b128 v25, v[52:55] offset:8192
v_mfma_f32_16x16x32_bf16 v[132:135], a[84:87], v[32:35], v[132:135]
v_fmac_f32 v232, v240, v224
v_fmac_f32 v233, v240, v225
v_mfma_f32_16x16x32_bf16 v[128:131], a[80:83], v[32:35], v[128:131]
s_add_u32 s73, s29, 114688
buffer_load_dwordx4 v[208:211], v2, s[20:23], s73 offen offset:0 sc1
v_fmac_f32 v234, v240, v226
v_mfma_f32_16x16x32_bf16 v[148:151], a[92:95], v[32:35], v[148:151]
v_fmac_f32 v235, v240, v227
v_fmac_f32 v236, v240, v228
v_mfma_f32_16x16x32_bf16 v[144:147], a[88:91], v[32:35], v[144:147]
s_waitcnt vmcnt(14)
v_fmac_f32 v237, v240, v229
v_fmac_f32 v238, v240, v230
v_mfma_f32_16x16x32_bf16 v[152:155], a[88:91], v[36:39], v[152:155]
buffer_load_dwordx4 v[212:215], v2, s[20:23], s73 offen offset:1024 sc1
v_fmac_f32 v239, v240, v231
v_mfma_f32_16x16x32_bf16 v[156:159], a[92:95], v[36:39], v[156:159]
v_cvt_pk_bf16_f32 v56, v232, v233
v_cvt_pk_bf16_f32 v57, v234, v235
v_mfma_f32_16x16x32_bf16 v[136:139], a[80:83], v[36:39], v[136:139]
v_cvt_pk_bf16_f32 v58, v236, v237
v_cvt_pk_bf16_f32 v59, v238, v239
v_mfma_f32_16x16x32_bf16 v[140:143], a[84:87], v[36:39], v[140:143]
s_waitcnt vmcnt(11)
s_add_u32 s73, s30, 114688
buffer_load_dwordx4 v[216:219], v2, s[20:23], s73 offen offset:0 sc1
v_mfma_f32_16x16x32_bf16 v[100:103], a[116:119], v[160:163], v[100:103]
ds_write_b128 v25, v[56:59] offset:9216
v_mfma_f32_16x16x32_bf16 v[96:99], a[112:115], v[160:163], v[96:99]
v_fmac_f32 v224, v241, v232
v_fmac_f32 v225, v241, v233
v_mfma_f32_16x16x32_bf16 v[116:119], a[124:127], v[160:163], v[116:119]
buffer_load_dwordx4 v[220:223], v2, s[20:23], s73 offen offset:1024 sc1
v_fmac_f32 v226, v241, v234
v_mfma_f32_16x16x32_bf16 v[112:115], a[120:123], v[160:163], v[112:115]
s_waitcnt vmcnt(12)
v_fmac_f32 v227, v241, v235
v_fmac_f32 v228, v241, v236
v_mfma_f32_16x16x32_bf16 v[120:123], a[120:123], v[164:167], v[120:123]
v_fmac_f32 v229, v241, v237
v_fmac_f32 v230, v241, v238
v_mfma_f32_16x16x32_bf16 v[124:127], a[124:127], v[164:167], v[124:127]
s_add_u32 s73, s4, 114688
buffer_load_dwordx4 v[200:203], v3, s[20:23], s73 offen offset:0 sc1
v_fmac_f32 v231, v241, v239
v_mfma_f32_16x16x32_bf16 v[104:107], a[112:115], v[164:167], v[104:107]
v_cvt_pk_bf16_f32 v60, -v224, -v225
v_cvt_pk_bf16_f32 v61, -v226, -v227
v_mfma_f32_16x16x32_bf16 v[108:111], a[116:119], v[164:167], v[108:111]
s_waitcnt vmcnt(12)
v_cvt_pk_bf16_f32 v62, -v228, -v229
v_cvt_pk_bf16_f32 v63, -v230, -v231
v_mfma_f32_16x16x32_bf16 v[100:103], a[132:135], v[168:171], v[100:103]
buffer_load_dwordx4 v[204:207], v3, s[20:23], s73 offen offset:1024 sc1
v_mfma_f32_16x16x32_bf16 v[96:99], a[128:131], v[168:171], v[96:99]
ds_write_b128 v25, v[60:63] offset:10240
v_mfma_f32_16x16x32_bf16 v[116:119], a[140:143], v[168:171], v[116:119]
v_fmac_f32 v232, v240, v224
v_fmac_f32 v233, v240, v225
v_mfma_f32_16x16x32_bf16 v[112:115], a[136:139], v[168:171], v[112:115]
s_waitcnt vmcnt(12)
s_add_u32 s73, s5, 114688
buffer_load_dwordx4 v[160:163], v3, s[20:23], s73 offen offset:0 sc1
v_mfma_f32_16x16x32_bf16 v[120:123], a[136:139], v[172:175], v[120:123]
v_fmac_f32 v234, v240, v226
v_fmac_f32 v235, v240, v227
v_mfma_f32_16x16x32_bf16 v[124:127], a[140:143], v[172:175], v[124:127]
v_fmac_f32 v236, v240, v228
v_fmac_f32 v237, v240, v229
v_mfma_f32_16x16x32_bf16 v[104:107], a[128:131], v[172:175], v[104:107]
buffer_load_dwordx4 v[164:167], v3, s[20:23], s73 offen offset:1024 sc1
v_fmac_f32 v238, v240, v230
v_mfma_f32_16x16x32_bf16 v[108:111], a[132:135], v[172:175], v[108:111]
s_waitcnt vmcnt(13)
v_fmac_f32 v239, v240, v231
v_cvt_pk_bf16_f32 v64, -v232, -v233
v_mfma_f32_16x16x32_bf16 v[100:103], a[148:151], v[176:179], v[100:103]
v_cvt_pk_bf16_f32 v65, -v234, -v235
v_cvt_pk_bf16_f32 v66, -v236, -v237
v_mfma_f32_16x16x32_bf16 v[96:99], a[144:147], v[176:179], v[96:99]
s_add_u32 s73, s6, 114688
buffer_load_dwordx4 v[168:171], v3, s[20:23], s73 offen offset:0 sc1
v_cvt_pk_bf16_f32 v67, -v238, -v239
v_mfma_f32_16x16x32_bf16 v[116:119], a[156:159], v[176:179], v[116:119]
buffer_load_dword v29, v27, s[20:23], 0 offen sc1
v_mfma_f32_16x16x32_bf16 v[112:115], a[152:155], v[176:179], v[112:115]
s_waitcnt vmcnt(14)
ds_write_b128 v25, v[64:67] offset:11264
v_mfma_f32_16x16x32_bf16 v[120:123], a[152:155], v[180:183], v[120:123]
buffer_load_dwordx4 v[172:175], v3, s[20:23], s73 offen offset:1024 sc1
v_fmac_f32 v224, v241, v232
v_mfma_f32_16x16x32_bf16 v[124:127], a[156:159], v[180:183], v[124:127]
v_fmac_f32 v225, v241, v233
v_fmac_f32 v226, v241, v234
v_mfma_f32_16x16x32_bf16 v[104:107], a[144:147], v[180:183], v[104:107]
v_fmac_f32 v227, v241, v235
v_fmac_f32 v228, v241, v236
v_mfma_f32_16x16x32_bf16 v[108:111], a[148:151], v[180:183], v[108:111]
s_waitcnt vmcnt(14)
s_add_u32 s73, s7, 114688
buffer_load_dwordx4 v[176:179], v3, s[20:23], s73 offen offset:0 sc1
v_mfma_f32_16x16x32_bf16 v[112:115], a[168:171], v[184:187], v[112:115]
v_fmac_f32 v229, v241, v237
v_fmac_f32 v230, v241, v238
v_mfma_f32_16x16x32_bf16 v[116:119], a[172:175], v[184:187], v[116:119]
s_waitcnt vmcnt(14)
v_fmac_f32 v231, v241, v239
v_cvt_pk_bf16_f32 v68, v224, v225
v_mfma_f32_16x16x32_bf16 v[120:123], a[168:171], v[188:191], v[120:123]
buffer_load_dwordx4 v[180:183], v3, s[20:23], s73 offen offset:1024 sc1
v_cvt_pk_bf16_f32 v69, v226, v227
v_mfma_f32_16x16x32_bf16 v[124:127], a[172:175], v[188:191], v[124:127]
s_waitcnt vmcnt(14)
v_cvt_pk_bf16_f32 v70, v228, v229
v_cvt_pk_bf16_f32 v71, v230, v231
v_mfma_f32_16x16x32_bf16 v[112:115], a[184:187], v[192:195], v[112:115]
ds_write_b128 v10, v[68:71] offset:0
v_mfma_f32_16x16x32_bf16 v[116:119], a[188:191], v[192:195], v[116:119]
s_waitcnt vmcnt(13)
s_add_u32 s73, s28, 114688
buffer_load_dwordx4 a[64:67], v3, s[20:23], s73 offen offset:0 sc1
v_mfma_f32_16x16x32_bf16 v[120:123], a[184:187], v[196:199], v[120:123]
v_fmac_f32 v232, v240, v224
v_fmac_f32 v233, v240, v225
v_mfma_f32_16x16x32_bf16 v[124:127], a[188:191], v[196:199], v[124:127]
s_waitcnt vmcnt(13)
v_fmac_f32 v234, v240, v226
v_fmac_f32 v235, v240, v227
v_mfma_f32_16x16x32_bf16 v[112:115], a[200:203], v[208:211], v[112:115]
buffer_load_dwordx4 a[68:71], v3, s[20:23], s73 offen offset:1024 sc1
v_fmac_f32 v236, v240, v228
v_mfma_f32_16x16x32_bf16 v[116:119], a[204:207], v[208:211], v[116:119]
s_waitcnt vmcnt(13)
v_fmac_f32 v237, v240, v229
v_fmac_f32 v238, v240, v230
v_mfma_f32_16x16x32_bf16 v[120:123], a[200:203], v[212:215], v[120:123]
v_fmac_f32 v239, v240, v231
v_cvt_pk_bf16_f32 v72, v232, v233
v_mfma_f32_16x16x32_bf16 v[124:127], a[204:207], v[212:215], v[124:127]
s_waitcnt vmcnt(12)
s_add_u32 s73, s29, 114688
buffer_load_dwordx4 a[72:75], v3, s[20:23], s73 offen offset:0 sc1
v_mfma_f32_16x16x32_bf16 v[112:115], a[216:219], v[216:219], v[112:115]
v_cvt_pk_bf16_f32 v73, v234, v235
v_cvt_pk_bf16_f32 v74, v236, v237
v_mfma_f32_16x16x32_bf16 v[116:119], a[220:223], v[216:219], v[116:119]
s_waitcnt vmcnt(12)
v_cvt_pk_bf16_f32 v75, v238, v239
v_mfma_f32_16x16x32_bf16 v[120:123], a[216:219], v[220:223], v[120:123]
buffer_load_dwordx4 a[76:79], v3, s[20:23], s73 offen offset:1024 sc1
v_mfma_f32_16x16x32_bf16 v[124:127], a[220:223], v[220:223], v[124:127]
s_mul_i32 s42, s32, 2560
ds_write_b128 v10, v[72:75] offset:4096
v_mfma_f32_16x16x32_bf16 v[96:99], a[160:163], v[184:187], v[96:99]
s_add_u32 s42, s42, 148736
v_xor_b32 v11, 0x400, v10
v_xor_b32 v13, 0x800, v10
v_mfma_f32_16x16x32_bf16 v[100:103], a[164:167], v[184:187], v[100:103]
s_add_u32 s73, s30, 114688
buffer_load_dwordx4 a[80:83], v3, s[20:23], s73 offen offset:0 sc1
v_and_b32 v242, 15, v0
v_mfma_f32_16x16x32_bf16 v[104:107], a[160:163], v[188:191], v[104:107]
s_lshl_b32 s40, s1, 5
ds_write_b128 v25, v[112:115] offset:12288
v_mfma_f32_16x16x32_bf16 v[108:111], a[164:167], v[188:191], v[108:111]
s_mov_b32 s43, 57344
v_mul_u32_u24 v31, 80, v242
v_lshl_add_u32 v31, v243, 3, v31
v_mfma_f32_16x16x32_bf16 v[96:99], a[176:179], v[192:195], v[96:99]
ds_write_b128 v25, v[116:119] offset:13312
v_mfma_f32_16x16x32_bf16 v[100:103], a[180:183], v[192:195], v[100:103]
buffer_load_dwordx4 a[84:87], v3, s[20:23], s73 offen offset:1024 sc1
v_add_u32 v31, s42, v31
v_mfma_f32_16x16x32_bf16 v[104:107], a[176:179], v[196:199], v[104:107]
ds_write_b128 v25, v[120:123] offset:14336
v_mfma_f32_16x16x32_bf16 v[108:111], a[180:183], v[196:199], v[108:111]
v_subrev_u32 v17, s40, v31
v_add_u32 v31, s40, v31
v_mfma_f32_16x16x32_bf16 v[96:99], a[192:195], v[208:211], v[96:99]
ds_write_b128 v25, v[124:127] offset:15360
v_mfma_f32_16x16x32_bf16 v[100:103], a[196:199], v[208:211], v[100:103]
v_lshrrev_b32 v244, 2, v0
v_mul_u32_u24 v244, 80, v244
v_mfma_f32_16x16x32_bf16 v[104:107], a[192:195], v[212:215], v[104:107]
v_and_b32 v245, 48, v1
v_add3_u32 v16, v244, v245, s42
v_mfma_f32_16x16x32_bf16 v[108:111], a[196:199], v[212:215], v[108:111]
v_mfma_f32_16x16x32_bf16 v[96:99], a[208:211], v[216:219], v[96:99]
s_waitcnt lgkmcnt(0)
s_barrier
v_mfma_f32_16x16x32_bf16 v[100:103], a[212:215], v[216:219], v[100:103]
ds_read_b128 v[112:115], v26 offset:12288
v_mfma_f32_16x16x32_bf16 v[104:107], a[208:211], v[220:223], v[104:107]
s_waitcnt vmcnt(9)
ds_read_b128 v[116:119], v26 offset:13312
v_cmp_ne_u32 vcc, 1, v29
v_mfma_f32_16x16x32_bf16 v[108:111], a[212:215], v[220:223], v[108:111]
s_add_u32 m0, s53, 0
ds_read_b128 v[120:123], v26 offset:14336
v_mfma_f32_16x16x32_bf16 v[132:135], a[100:103], v[40:43], v[132:135]
s_cbranch_vccnz L_slow_pZ
L_back_pZ:
ds_read_b128 v[124:127], v26 offset:15360
v_mfma_f32_16x16x32_bf16 v[128:131], a[96:99], v[40:43], v[128:131]
s_mov_b32 s52, 0
buffer_load_dwordx4 v23, s[20:23], s52 offen sc1 lds
v_mfma_f32_16x16x32_bf16 v[148:151], a[108:111], v[40:43], v[148:151]
s_add_u32 m0, s53, 1024
s_mov_b32 s52, 131072
buffer_load_dwordx4 v23, s[20:23], s52 offen sc1 lds
v_mfma_f32_16x16x32_bf16 v[144:147], a[104:107], v[40:43], v[144:147]
s_waitcnt lgkmcnt(2)
v_add_f32 v96, v96, v112
v_mfma_f32_16x16x32_bf16 v[152:155], a[104:107], v[44:47], v[152:155]
s_add_u32 m0, s53, 2048
v_add_f32 v97, v97, v113
v_add_f32 v98, v98, v114
v_mfma_f32_16x16x32_bf16 v[156:159], a[108:111], v[44:47], v[156:159]
s_mov_b32 s52, 262144
buffer_load_dwordx4 v23, s[20:23], s52 offen sc1 lds
v_add_f32 v99, v99, v115
v_mfma_f32_16x16x32_bf16 v[136:139], a[96:99], v[44:47], v[136:139]
v_add_f32 v100, v100, v116
v_add_f32 v101, v101, v117
v_mfma_f32_16x16x32_bf16 v[140:143], a[100:103], v[44:47], v[140:143]
s_add_u32 m0, s53, 3072
v_add_f32 v102, v102, v118
v_mfma_f32_16x16x32_bf16 v[132:135], a[116:119], v[200:203], v[132:135]
s_mov_b32 s52, 393216
buffer_load_dwordx4 v23, s[20:23], s52 offen sc1 lds
v_add_f32 v103, v103, v119
v_mfma_f32_16x16x32_bf16 v[128:131], a[112:115], v[200:203], v[128:131]
v_cvt_pk_bf16_f32 v96, v96, v97
v_cvt_pk_bf16_f32 v97, v98, v99
v_mfma_f32_16x16x32_bf16 v[148:151], a[124:127], v[200:203], v[148:151]
s_add_u32 m0, s53, 4096
v_cvt_pk_bf16_f32 v98, v100, v101
v_cvt_pk_bf16_f32 v99, v102, v103
v_mfma_f32_16x16x32_bf16 v[144:147], a[120:123], v[200:203], v[144:147]
s_mov_b32 s52, 524288
buffer_load_dwordx4 v23, s[20:23], s52 offen sc1 lds
v_mfma_f32_16x16x32_bf16 v[152:155], a[120:123], v[204:207], v[152:155]
ds_read_b128 a[224:227], v5 offset:0
v_min_u32 v96, -2, v96
v_mfma_f32_16x16x32_bf16 v[156:159], a[124:127], v[204:207], v[156:159]
s_add_u32 m0, s53, 5120
s_waitcnt lgkmcnt(1)
buffer_store_dwordx4 v[96:99], v1, s[20:23], s74 offen offset:0 sc1
v_mfma_f32_16x16x32_bf16 v[136:139], a[112:115], v[204:207], v[136:139]
s_mov_b32 s52, 655360
buffer_load_dwordx4 v23, s[20:23], s52 offen sc1 lds
v_add_f32 v104, v104, v120
v_mfma_f32_16x16x32_bf16 v[140:143], a[116:119], v[204:207], v[140:143]
v_add_f32 v105, v105, v121
v_add_f32 v106, v106, v122
v_mfma_f32_16x16x32_bf16 v[132:135], a[132:135], v[160:163], v[132:135]
s_add_u32 m0, s53, 6144
v_add_f32 v107, v107, v123
v_add_f32 v108, v108, v124
v_mfma_f32_16x16x32_bf16 v[128:131], a[128:131], v[160:163], v[128:131]
s_mov_b32 s52, 786432
buffer_load_dwordx4 v23, s[20:23], s52 offen sc1 lds
v_add_f32 v109, v109, v125
v_mfma_f32_16x16x32_bf16 v[148:151], a[140:143], v[160:163], v[148:151]
v_add_f32 v110, v110, v126
v_add_f32 v111, v111, v127
v_mfma_f32_16x16x32_bf16 v[144:147], a[136:139], v[160:163], v[144:147]
s_add_u32 m0, s53, 7168
v_cvt_pk_bf16_f32 v104, v104, v105
v_mfma_f32_16x16x32_bf16 v[152:155], a[136:139], v[164:167], v[152:155]
s_mov_b32 s52, 917504
buffer_load_dwordx4 v23, s[20:23], s52 offen sc1 lds
v_cvt_pk_bf16_f32 v105, v106, v107
v_mfma_f32_16x16x32_bf16 v[156:159], a[140:143], v[164:167], v[156:159]
v_cvt_pk_bf16_f32 v106, v108, v109
v_cvt_pk_bf16_f32 v107, v110, v111
v_mfma_f32_16x16x32_bf16 v[136:139], a[128:131], v[164:167], v[136:139]
s_add_u32 m0, s53, 8192
ds_read_b128 a[228:231], v5 offset:1024
v_min_u32 v104, -2, v104
v_mfma_f32_16x16x32_bf16 v[140:143], a[132:135], v[164:167], v[140:143]
s_mov_b32 s52, 1048576
buffer_load_dwordx4 v23, s[20:23], s52 offen sc1 lds
v_mfma_f32_16x16x32_bf16 v[132:135], a[148:151], v[168:171], v[132:135]
buffer_store_dwordx4 v[104:107], v1, s[20:23], s74 offen offset:1024 sc1
ds_read_b128 a[232:235], v5 offset:2048
v_mfma_f32_16x16x32_bf16 v[128:131], a[144:147], v[168:171], v[128:131]
s_add_u32 m0, s53, 9216
ds_read_b128 a[236:239], v5 offset:3072
v_mfma_f32_16x16x32_bf16 v[148:151], a[156:159], v[168:171], v[148:151]
s_mov_b32 s52, 1179648
buffer_load_dwordx4 v23, s[20:23], s52 offen sc1 lds
ds_read_b128 a[240:243], v5 offset:4096
v_mfma_f32_16x16x32_bf16 v[144:147], a[152:155], v[168:171], v[144:147]
s_waitcnt vmcnt(20)
ds_read_b128 a[244:247], v5 offset:5120
v_mfma_f32_16x16x32_bf16 v[152:155], a[152:155], v[172:175], v[152:155]
s_add_u32 m0, s53, 10240
ds_read_b128 a[248:251], v5 offset:6144
v_mfma_f32_16x16x32_bf16 v[156:159], a[156:159], v[172:175], v[156:159]
s_mov_b32 s52, 1310720
buffer_load_dwordx4 v23, s[20:23], s52 offen sc1 lds
ds_read_b128 a[252:255], v5 offset:7168
v_mfma_f32_16x16x32_bf16 v[136:139], a[144:147], v[172:175], v[136:139]
ds_read_b128 a[112:115], v5 offset:8192
v_mfma_f32_16x16x32_bf16 v[140:143], a[148:151], v[172:175], v[140:143]
s_waitcnt vmcnt(20)
s_add_u32 m0, s53, 11264
ds_read_b128 a[116:119], v5 offset:9216
v_mfma_f32_16x16x32_bf16 v[132:135], a[164:167], v[176:179], v[132:135]
s_mov_b32 s52, 1441792
buffer_load_dwordx4 v23, s[20:23], s52 offen sc1 lds
ds_read_b128 a[120:123], v5 offset:10240
v_mfma_f32_16x16x32_bf16 v[128:131], a[160:163], v[176:179], v[128:131]
ds_read_b128 a[124:127], v5 offset:11264
v_mfma_f32_16x16x32_bf16 v[148:151], a[172:175], v[176:179], v[148:151]
s_add_u32 m0, s53, 12288
ds_read_b128 a[128:131], v11 offset:0
v_mfma_f32_16x16x32_bf16 v[144:147], a[168:171], v[176:179], v[144:147]
s_waitcnt vmcnt(20)
s_mov_b32 s52, 1572864
buffer_load_dwordx4 v23, s[20:23], s52 offen sc1 lds
v_mfma_f32_16x16x32_bf16 v[152:155], a[168:171], v[180:183], v[152:155]
ds_read_b128 a[132:135], v11 offset:4096
v_mfma_f32_16x16x32_bf16 v[156:159], a[172:175], v[180:183], v[156:159]
s_add_u32 m0, s53, 13312
v_mfma_f32_16x16x32_bf16 v[136:139], a[160:163], v[180:183], v[136:139]
s_mov_b32 s52, 1703936
buffer_load_dwordx4 v23, s[20:23], s52 offen sc1 lds
v_mfma_f32_16x16x32_bf16 v[140:143], a[164:167], v[180:183], v[140:143]
s_waitcnt vmcnt(21)
v_mfma_f32_16x16x32_bf16 v[132:135], a[180:183], a[64:67], v[132:135]
v_mfma_f32_16x16x32_bf16 v[128:131], a[176:179], a[64:67], v[128:131]
v_mfma_f32_16x16x32_bf16 v[148:151], a[188:191], a[64:67], v[148:151]
v_mfma_f32_16x16x32_bf16 v[144:147], a[184:187], a[64:67], v[144:147]
s_waitcnt vmcnt(20)
v_mfma_f32_16x16x32_bf16 v[152:155], a[184:187], a[68:71], v[152:155]
v_mfma_f32_16x16x32_bf16 v[156:159], a[188:191], a[68:71], v[156:159]
v_mfma_f32_16x16x32_bf16 v[136:139], a[176:179], a[68:71], v[136:139]
v_mfma_f32_16x16x32_bf16 v[140:143], a[180:183], a[68:71], v[140:143]
s_waitcnt vmcnt(19)
v_mfma_f32_16x16x32_bf16 v[132:135], a[196:199], a[72:75], v[132:135]
v_mfma_f32_16x16x32_bf16 v[128:131], a[192:195], a[72:75], v[128:131]
L_pad4:
s_cbranch_execz L_padret
v_mfma_f32_16x16x32_bf16 v[148:151], a[204:207], a[72:75], v[148:151]
buffer_load_dword v8, v7, s[20:23], s78 offen offset:0 sc1
v_mfma_f32_16x16x32_bf16 v[144:147], a[200:203], a[72:75], v[144:147]
s_waitcnt vmcnt(19)
buffer_load_dword v9, v7, s[20:23], s78 offen offset:64 sc1
v_mfma_f32_16x16x32_bf16 v[152:155], a[200:203], a[76:79], v[152:155]
v_mfma_f32_16x16x32_bf16 v[156:159], a[204:207], a[76:79], v[156:159]
s_waitcnt vmcnt(10)
s_barrier
v_mfma_f32_16x16x32_bf16 v[136:139], a[192:195], a[76:79], v[136:139]
s_waitcnt lgkmcnt(10)
ds_read_b64_tr_b16 a[0:1], v22 offset:0
ds_read_b64_tr_b16 a[2:3], v22 offset:28672
v_mfma_f32_16x16x32_bf16 v[140:143], a[196:199], a[76:79], v[140:143]
s_waitcnt lgkmcnt(10)
ds_read_b64_tr_b16 a[4:5], v6 offset:0
ds_read_b64_tr_b16 a[6:7], v6 offset:28672
v_mfma_f32_16x16x32_bf16 v[132:135], a[212:215], a[80:83], v[132:135]
s_waitcnt lgkmcnt(10)
ds_read_b64_tr_b16 a[8:9], v22 offset:1024
ds_read_b64_tr_b16 a[10:11], v22 offset:29696
v_mfma_f32_16x16x32_bf16 v[128:131], a[208:211], a[80:83], v[128:131]
s_waitcnt lgkmcnt(10)
ds_read_b64_tr_b16 a[12:13], v6 offset:1024
ds_read_b64_tr_b16 a[14:15], v6 offset:29696
v_mfma_f32_16x16x32_bf16 v[148:151], a[220:223], a[80:83], v[148:151]
s_waitcnt lgkmcnt(10)
ds_read_b64_tr_b16 a[16:17], v22 offset:2048
ds_read_b64_tr_b16 a[18:19], v22 offset:30720
v_mfma_f32_16x16x32_bf16 v[144:147], a[216:219], a[80:83], v[144:147]
s_waitcnt lgkmcnt(10)
ds_read_b64_tr_b16 a[20:21], v6 offset:2048
ds_read_b64_tr_b16 a[22:23], v6 offset:30720
v_mfma_f32_16x16x32_bf16 v[152:155], a[216:219], a[84:87], v[152:155]
s_waitcnt lgkmcnt(10)
ds_read_b64_tr_b16 a[24:25], v22 offset:3072
ds_read_b64_tr_b16 a[26:27], v22 offset:31744
v_mfma_f32_16x16x32_bf16 v[156:159], a[220:223], a[84:87], v[156:159]
s_waitcnt lgkmcnt(10)
ds_read_b64_tr_b16 a[28:29], v6 offset:3072
ds_read_b64_tr_b16 a[30:31], v6 offset:31744
v_mfma_f32_16x16x32_bf16 v[136:139], a[208:211], a[84:87], v[136:139]
s_waitcnt lgkmcnt(10)
ds_read_b64_tr_b16 a[32:33], v22 offset:4096
ds_read_b64_tr_b16 a[34:35], v22 offset:32768
v_mfma_f32_16x16x32_bf16 v[140:143], a[212:215], a[84:87], v[140:143]
s_waitcnt lgkmcnt(10)
ds_read_b64_tr_b16 a[36:37], v6 offset:4096
ds_read_b64_tr_b16 a[38:39], v6 offset:32768
v_mfma_f32_16x16x32_bf16 v[208:211], v[80:83], a[0:3], 0
s_waitcnt lgkmcnt(10)
ds_read_b64_tr_b16 a[40:41], v22 offset:5120
ds_read_b64_tr_b16 a[42:43], v22 offset:33792
v_mfma_f32_16x16x32_bf16 v[212:215], a[224:227], a[0:3], 0
s_waitcnt lgkmcnt(10)
ds_read_b64_tr_b16 a[44:45], v6 offset:5120
ds_read_b64_tr_b16 a[46:47], v6 offset:33792
v_mfma_f32_16x16x32_bf16 v[216:219], v[80:83], a[4:7], 0
s_waitcnt lgkmcnt(10)
ds_read_b64_tr_b16 a[48:49], v22 offset:6144
ds_read_b64_tr_b16 a[50:51], v22 offset:34816
v_mfma_f32_16x16x32_bf16 v[220:223], a[224:227], a[4:7], 0
s_waitcnt lgkmcnt(10)
ds_read_b64_tr_b16 a[52:53], v6 offset:6144
ds_read_b64_tr_b16 a[54:55], v6 offset:34816
v_mfma_f32_16x16x32_bf16 v[208:211], v[84:87], a[8:11], v[208:211]
ds_write_b128 v10, v[144:147] offset:8192
v_mfma_f32_16x16x32_bf16 v[212:215], a[228:231], a[8:11], v[212:215]
v_mfma_f32_16x16x32_bf16 v[216:219], v[84:87], a[12:15], v[216:219]
v_mfma_f32_16x16x32_bf16 v[220:223], a[228:231], a[12:15], v[220:223]
ds_write_b128 v10, v[148:151] offset:12288
v_mfma_f32_16x16x32_bf16 v[208:211], v[88:91], a[16:19], v[208:211]
v_mfma_f32_16x16x32_bf16 v[212:215], a[232:235], a[16:19], v[212:215]
v_mfma_f32_16x16x32_bf16 v[216:219], v[88:91], a[20:23], v[216:219]
ds_write_b128 v10, v[152:155] offset:16384
v_mfma_f32_16x16x32_bf16 v[220:223], a[232:235], a[20:23], v[220:223]
buffer_load_dwordx4 v[96:99], v1, s[20:23], s75 offen offset:0 sc1
v_mfma_f32_16x16x32_bf16 v[208:211], v[92:95], a[24:27], v[208:211]
v_mfma_f32_16x16x32_bf16 v[212:215], a[236:239], a[24:27], v[212:215]
buffer_load_dwordx4 v[100:103], v1, s[20:23], s75 offen offset:1024 sc1
s_waitcnt lgkmcnt(10)
ds_write_b128 v10, v[156:159] offset:20480
v_mfma_f32_16x16x32_bf16 v[216:219], v[92:95], a[28:31], v[216:219]
v_mfma_f32_16x16x32_bf16 v[220:223], a[236:239], a[28:31], v[220:223]
v_mfma_f32_16x16x32_bf16 v[208:211], v[248:251], a[32:35], v[208:211]
v_mfma_f32_16x16x32_bf16 v[212:215], a[240:243], a[32:35], v[212:215]
s_waitcnt vmcnt(4) lgkmcnt(0)
s_barrier
v_mfma_f32_16x16x32_bf16 v[216:219], v[248:251], a[36:39], v[216:219]
s_nop 0
ds_read_b64_tr_b16 a[56:57], v22 offset:7168
ds_read_b64_tr_b16 a[58:59], v22 offset:35840
v_mfma_f32_16x16x32_bf16 v[220:223], a[240:243], a[36:39], v[220:223]
s_nop 0
ds_read_b64_tr_b16 a[60:61], v6 offset:7168
ds_read_b64_tr_b16 a[62:63], v6 offset:35840
v_mfma_f32_16x16x32_bf16 v[208:211], v[252:255], a[40:43], v[208:211]
s_nop 0
ds_read_b64_tr_b16 a[64:65], v22 offset:8192
ds_read_b64_tr_b16 a[66:67], v22 offset:36864
v_mfma_f32_16x16x32_bf16 v[212:215], a[244:247], a[40:43], v[212:215]
s_nop 0
ds_read_b64_tr_b16 a[68:69], v6 offset:8192
ds_read_b64_tr_b16 a[70:71], v6 offset:36864
v_mfma_f32_16x16x32_bf16 v[216:219], v[252:255], a[44:47], v[216:219]
s_nop 0
ds_read_b64_tr_b16 a[72:73], v22 offset:9216
ds_read_b64_tr_b16 a[74:75], v22 offset:37888
v_mfma_f32_16x16x32_bf16 v[220:223], a[244:247], a[44:47], v[220:223]
s_nop 0
ds_read_b128 v[144:147], v13 offset:8192
ds_read_b64_tr_b16 a[76:77], v6 offset:9216
v_mfma_f32_16x16x32_bf16 v[208:211], v[18:21], a[48:51], v[208:211]
s_waitcnt lgkmcnt(10)
ds_read_b128 v[148:151], v13 offset:12288
ds_read_b64_tr_b16 a[78:79], v6 offset:37888
v_mfma_f32_16x16x32_bf16 v[212:215], a[248:251], a[48:51], v[212:215]
s_waitcnt lgkmcnt(10)
ds_read_b128 v[152:155], v13 offset:16384
ds_read_b64_tr_b16 a[80:81], v22 offset:10240
v_mfma_f32_16x16x32_bf16 v[216:219], v[18:21], a[52:55], v[216:219]
s_waitcnt lgkmcnt(10)
ds_read_b128 v[156:159], v13 offset:20480
ds_read_b64_tr_b16 a[82:83], v22 offset:38912
v_mfma_f32_16x16x32_bf16 v[220:223], a[248:251], a[52:55], v[220:223]
s_waitcnt vmcnt(2)
ds_read_b64_tr_b16 a[84:85], v6 offset:10240
v_mfma_f32_16x16x32_bf16 v[208:211], v[48:51], a[56:59], v[208:211]
ds_read_b64_tr_b16 a[86:87], v6 offset:38912
v_min_u32 v29, v8, v9
v_mfma_f32_16x16x32_bf16 v[212:215], a[252:255], a[56:59], v[212:215]
ds_read_b64_tr_b16 a[88:89], v22 offset:11264
v_add_u32 v29, -1, v29
v_mfma_f32_16x16x32_bf16 v[216:219], v[48:51], a[60:63], v[216:219]
s_waitcnt lgkmcnt(10)
ds_read_b64_tr_b16 a[90:91], v22 offset:39936
v_sub_f32 v14, 1.0, v8
v_mfma_f32_16x16x32_bf16 v[220:223], a[252:255], a[60:63], v[220:223]
ds_read_b64_tr_b16 a[92:93], v6 offset:11264
v_sub_f32 v15, 1.0, v9
v_mfma_f32_16x16x32_bf16 v[208:211], v[52:55], a[64:67], v[208:211]
ds_read_b64_tr_b16 a[94:95], v6 offset:39936
v_cvt_pk_bf16_f32 v14, 0, v14
v_mfma_f32_16x16x32_bf16 v[212:215], a[112:115], a[64:67], v[212:215]
s_waitcnt lgkmcnt(11)
ds_read_b64_tr_b16 a[96:97], v22 offset:12288
v_cvt_pk_bf16_f32 v15, 0, v15
v_mfma_f32_16x16x32_bf16 v[216:219], v[52:55], a[68:71], v[216:219]
ds_read_b64_tr_b16 a[98:99], v22 offset:40960
v_add_f32 v128, v128, v144
v_mfma_f32_16x16x32_bf16 v[220:223], a[112:115], a[68:71], v[220:223]
s_waitcnt lgkmcnt(12)
ds_read_b64_tr_b16 a[100:101], v6 offset:12288
v_add_f32 v129, v129, v145
v_mfma_f32_16x16x32_bf16 v[208:211], v[56:59], a[72:75], v[208:211]
ds_read_b64_tr_b16 a[102:103], v6 offset:40960
v_add_f32 v130, v130, v146
v_mfma_f32_16x16x32_bf16 v[212:215], a[116:119], a[72:75], v[212:215]
ds_read_b64_tr_b16 a[104:105], v22 offset:13312
v_add_f32 v131, v131, v147
v_mfma_f32_16x16x32_bf16 v[216:219], v[56:59], a[76:79], v[216:219]
s_waitcnt lgkmcnt(10)
ds_read_b64_tr_b16 a[106:107], v22 offset:41984
v_add_f32 v132, v132, v148
v_mfma_f32_16x16x32_bf16 v[220:223], a[116:119], a[76:79], v[220:223]
s_waitcnt lgkmcnt(10)
ds_read_b64_tr_b16 a[108:109], v6 offset:13312
v_add_f32 v133, v133, v149
v_mfma_f32_16x16x32_bf16 v[208:211], v[60:63], a[80:83], v[208:211]
ds_read_b64_tr_b16 a[110:111], v6 offset:41984
v_add_f32 v134, v134, v150
v_mfma_f32_16x16x32_bf16 v[212:215], a[120:123], a[80:83], v[212:215]
v_add_f32 v135, v135, v151
v_add_f32 v136, v136, v152
v_mfma_f32_16x16x32_bf16 v[216:219], v[60:63], a[84:87], v[216:219]
v_add_f32 v137, v137, v153
v_add_f32 v138, v138, v154
v_mfma_f32_16x16x32_bf16 v[220:223], a[120:123], a[84:87], v[220:223]
s_waitcnt lgkmcnt(8)
v_add_f32 v139, v139, v155
v_add_f32 v140, v140, v156
v_mfma_f32_16x16x32_bf16 v[208:211], v[64:67], a[88:91], v[208:211]
v_add_f32 v141, v141, v157
v_add_f32 v142, v142, v158
v_mfma_f32_16x16x32_bf16 v[212:215], a[124:127], a[88:91], v[212:215]
s_waitcnt vmcnt(0)
v_max3_u32 v29, v96, v100, v29
v_cmp_eq_u32 vcc, -1, v29
v_mfma_f32_16x16x32_bf16 v[216:219], v[64:67], a[92:95], v[216:219]
v_add_f32 v143, v143, v159
v_mfma_f32_16x16x32_bf16 v[220:223], a[124:127], a[92:95], v[220:223]
s_waitcnt lgkmcnt(4)
s_cbranch_vccnz L_slow_pP
L_back_pP:
v_lshlrev_b32 v112, 16, v96
v_mfma_f32_16x16x32_bf16 v[208:211], v[68:71], a[96:99], v[208:211]
v_and_b32 v113, 0xffff0000, v96
v_lshlrev_b32 v114, 16, v97
v_mfma_f32_16x16x32_bf16 v[212:215], a[128:131], a[96:99], v[212:215]
v_and_b32 v115, 0xffff0000, v97
v_lshlrev_b32 v116, 16, v98
v_mfma_f32_16x16x32_bf16 v[216:219], v[68:71], a[100:103], v[216:219]
v_and_b32 v117, 0xffff0000, v98
v_lshlrev_b32 v118, 16, v99
v_mfma_f32_16x16x32_bf16 v[220:223], a[128:131], a[100:103], v[220:223]
s_waitcnt lgkmcnt(0)
v_and_b32 v119, 0xffff0000, v99
v_lshlrev_b32 v120, 16, v100
v_mfma_f32_16x16x32_bf16 v[208:211], v[72:75], a[104:107], v[208:211]
v_and_b32 v121, 0xffff0000, v100
v_lshlrev_b32 v122, 16, v101
v_mfma_f32_16x16x32_bf16 v[212:215], a[132:135], a[104:107], v[212:215]
v_and_b32 v123, 0xffff0000, v101
v_lshlrev_b32 v124, 16, v102
v_mfma_f32_16x16x32_bf16 v[216:219], v[72:75], a[108:111], v[216:219]
v_and_b32 v125, 0xffff0000, v102
v_lshlrev_b32 v126, 16, v103
v_mfma_f32_16x16x32_bf16 v[220:223], a[132:135], a[108:111], v[220:223]
v_and_b32 v127, 0xffff0000, v103
v_pk_add_f32 v[128:129], v[128:129], v[112:113]
v_pk_add_f32 v[130:131], v[130:131], v[114:115]
v_pk_add_f32 v[132:133], v[132:133], v[116:117]
v_pk_add_f32 v[134:135], v[134:135], v[118:119]
v_pk_add_f32 v[136:137], v[136:137], v[120:121]
v_pk_add_f32 v[138:139], v[138:139], v[122:123]
v_pk_add_f32 v[140:141], v[140:141], v[124:125]
v_pk_add_f32 v[142:143], v[142:143], v[126:127]
v_pk_mul_f32 v[208:209], v[208:209], v[8:9] op_sel_hi:[1,0]
v_pk_mul_f32 v[210:211], v[210:211], v[8:9] op_sel_hi:[1,0]
v_pk_mul_f32 v[212:213], v[212:213], v[8:9] op_sel_hi:[1,0]
v_pk_mul_f32 v[214:215], v[214:215], v[8:9] op_sel_hi:[1,0]
v_pk_fma_f32 v[208:209], v[128:129], v[14:15], v[208:209] op_sel_hi:[1,0,1]
v_pk_fma_f32 v[210:211], v[130:131], v[14:15], v[210:211] op_sel_hi:[1,0,1]
v_pk_fma_f32 v[212:213], v[132:133], v[14:15], v[212:213] op_sel_hi:[1,0,1]
v_pk_fma_f32 v[214:215], v[134:135], v[14:15], v[214:215] op_sel_hi:[1,0,1]
v_cvt_pk_bf16_f32 v104, v208, v209
v_cvt_pk_bf16_f32 v105, v210, v211
v_cvt_pk_bf16_f32 v106, v212, v213
v_cvt_pk_bf16_f32 v107, v214, v215
ds_write_b64 v31, v[104:105] offset:0
ds_write_b64 v17, v[106:107] offset:32
ds_read_b128 v[160:163], v16 offset:0
v_pk_mul_f32 v[216:217], v[216:217], v[8:9] op_sel:[0,1] op_sel_hi:[1,1]
v_pk_mul_f32 v[218:219], v[218:219], v[8:9] op_sel:[0,1] op_sel_hi:[1,1]
v_pk_mul_f32 v[220:221], v[220:221], v[8:9] op_sel:[0,1] op_sel_hi:[1,1]
v_pk_mul_f32 v[222:223], v[222:223], v[8:9] op_sel:[0,1] op_sel_hi:[1,1]
v_pk_fma_f32 v[216:217], v[136:137], v[14:15], v[216:217] op_sel:[0,1,0] op_sel_hi:[1,1,1]
v_pk_fma_f32 v[218:219], v[138:139], v[14:15], v[218:219] op_sel:[0,1,0] op_sel_hi:[1,1,1]
v_pk_fma_f32 v[220:221], v[140:141], v[14:15], v[220:221] op_sel:[0,1,0] op_sel_hi:[1,1,1]
v_pk_fma_f32 v[222:223], v[142:143], v[14:15], v[222:223] op_sel:[0,1,0] op_sel_hi:[1,1,1]
v_cvt_pk_bf16_f32 v108, v216, v217
v_cvt_pk_bf16_f32 v109, v218, v219
v_cvt_pk_bf16_f32 v110, v220, v221
v_cvt_pk_bf16_f32 v111, v222, v223
ds_write_b64 v31, v[108:109] offset:1280
ds_write_b64 v17, v[110:111] offset:1312
ds_read_b128 v[164:167], v16 offset:1280
s_waitcnt lgkmcnt(3)
buffer_store_dwordx4 v[160:163], v24, s[24:27], 0 offen
s_waitcnt lgkmcnt(0)
buffer_store_dwordx4 v[164:167], v24, s[24:27], s43 offen
L_fin:
L_end:
s_endpgm
L_aux:
s_mov_b32 s44, 0xbfb8aa3b
s_movk_i32 s46, 0x7f
s_lshr_b32 s41, s35, 3
s_lshl_b32 s41, s41, 1
s_and_b32 s42, s35, 1
s_add_u32 s41, s41, s42
s_lshl_b32 s41, s41, 2
s_add_u32 s41, s41, s32
s_lshl_b32 s41, s41, 3
s_bfe_u32 s42, s35, 0x20001
s_add_u32 s41, s41, s42
s_lshl_b32 s41, s41, 3
v_lshrrev_b32 v4, 5, v0
v_bfe_u32 v5, v0, 2, 3
v_lshl_add_u32 v4, v4, 5, v5
v_add_u32 v4, s41, v4
v_and_b32 v8, 48, v1
v_mul_u32_u24 v4, 896, v4
v_add_u32 v3, v4, v8
v_and_b32 v30, 31, v0
v_lshlrev_b32 v30, 3, v30
v_and_b32 v4, 7, v0
v_lshrrev_b32 v5, 7, v2
v_lshrrev_b32 v6, 1, v4
v_mul_u32_u24 v9, 1120, v6
v_and_b32 v6, 1, v0
v_mul_u32_u24 v6, 496, v6
v_add3_u32 v9, v9, v6, 16
v_add_u32 v6, v4, v5
v_lshl_add_u32 v9, v6, 1, v9
v_add_u32 v17, 35840, v9
v_lshlrev_b32 v10, 13, v5
v_lshl_add_u32 v10, v4, 4, v10
s_lshr_b32 s41, s34, 1
s_lshl_b32 s41, s41, 2
s_add_u32 s41, s41, s33
s_lshl_b32 s41, s41, 1
s_and_b32 s42, s34, 1
s_add_u32 s41, s41, s42
s_lshl_b32 s41, s41, 7
s_add_u32 s41, s41, 4718592
s_add_u32 s42, s41, 4096
s_movk_i32 s37, 224
s_mov_b32 s71, 0x35924925
s_lshr_b32 s73, s37, 4
s_cmp_eq_u32 s73, 14
s_cselect_b32 s73, 0, s73
s_lshl2_add_u32 s73, s73, s32
s_lshl_b32 s73, s73, 4
s_lshl_b32 s76, s32, 1
v_add_u32 v27, s73, v0
v_bfe_u32 v246, v0, 1, 2
v_and_b32 v247, 1, v0
v_lshl_add_u32 v246, v246, 3, v247
v_add_u32 v246, s76, v246
v_add_u32 v246, 896, v246
v_subrev_u32 v247, 16, v0
v_ashrrev_i32 v247, 31, v247
v_bfi_b32 v27, v247, v27, v246
v_lshlrev_b32 v27, 7, v27
v_and_b32 v247, 3, v0
v_mul_u32_u24 v240, 528, v247
v_lshrrev_b32 v246, 4, v0
v_lshl_add_u32 v240, v246, 7, v240
v_bfe_u32 v246, v0, 2, 1
v_lshl_add_u32 v240, v246, 6, v240
v_and_b32 v246, 8, v0
v_add_u32 v240, v246, v240
v_add_u32 v240, 148736, v240
v_xor_b32 v241, 16, v240
v_xor_b32 v242, 32, v240
v_xor_b32 v243, 48, v240
v_lshrrev_b32 v246, 5, v0
v_xor_b32 v246, v246, v0
v_bfe_i32 v245, v246, 0, 1
s_cmp_lg_u32 s35, 4
s_cbranch_scc1 L_aux1
v_lshrrev_b32 v193, 4, v0
v_and_b32 v192, 15, v0
v_lshl_add_u32 v194, s32, 4, v192
v_lshrrev_b32 v196, 2, v192
v_and_b32 v197, 3, v192
v_lshl_add_u32 v195, v196, 3, v197
v_bfe_i32 v199, v0, 0, 1
v_and_b32 v199, 0x80008000, v199
v_cvt_f32_u32 v194, v194
v_cvt_f32_u32 v195, v195
v_cvt_f32_u32 v193, v193
v_mul_f32 v196, 0x3c800000, v194
v_mul_f32 v197, 4.0, v193
v_mul_f32 v197, v197, v196
v_cos_f32 v192, v196
s_nop 0
v_add_f32 v192, v192, v192
v_add_f32 v209, v197, v196
v_cos_f32 v200, v197
v_sin_f32 v208, v197
v_cos_f32 v201, v209
v_sin_f32 v209, v209
v_fma_f32 v202, v192, v201, -v200
v_fma_f32 v210, v192, v209, -v208
v_fma_f32 v203, v192, v202, -v201
v_fma_f32 v211, v192, v210, -v209
v_mul_f32 v198, 0x3d800000, v197
v_fmamk_f32 v197, v196, 0x41800000, v197
v_add_f32 v213, v197, v196
v_cos_f32 v204, v197
v_sin_f32 v212, v197
v_cos_f32 v205, v213
v_sin_f32 v213, v213
v_fma_f32 v206, v192, v205, -v204
v_fma_f32 v214, v192, v213, -v212
v_fma_f32 v207, v192, v206, -v205
v_fma_f32 v215, v192, v214, -v213
v_cvt_pk_bf16_f32 v216, v200, v201
v_cvt_pk_bf16_f32 v217, v202, v203
v_cvt_pk_bf16_f32 v218, v204, v205
v_cvt_pk_bf16_f32 v219, v206, v207
v_cvt_pk_bf16_f32 v220, v208, v209
v_cvt_pk_bf16_f32 v221, v210, v211
v_cvt_pk_bf16_f32 v222, v212, v213
v_cvt_pk_bf16_f32 v223, v214, v215
v_accvgpr_write_b32 a224, v216
v_accvgpr_write_b32 a225, v217
v_accvgpr_write_b32 a226, v218
v_accvgpr_write_b32 a227, v219
v_accvgpr_write_b32 a232, v220
v_accvgpr_write_b32 a233, v221
v_accvgpr_write_b32 a234, v222
v_accvgpr_write_b32 a235, v223
v_xor_b32 v216, v199, v216
v_xor_b32 v217, v199, v217
v_xor_b32 v218, v199, v218
v_xor_b32 v219, v199, v219
v_xor_b32 v220, v199, v220
v_xor_b32 v221, v199, v221
v_xor_b32 v222, v199, v222
v_xor_b32 v223, v199, v223
v_accvgpr_write_b32 a228, v216
v_accvgpr_write_b32 a229, v217
v_accvgpr_write_b32 a230, v218
v_accvgpr_write_b32 a231, v219
v_accvgpr_write_b32 a236, v220
v_accvgpr_write_b32 a237, v221
v_accvgpr_write_b32 a238, v222
v_accvgpr_write_b32 a239, v223
v_xor_b32 v220, 0x80008000, v220
v_xor_b32 v221, 0x80008000, v221
v_xor_b32 v222, 0x80008000, v222
v_xor_b32 v223, 0x80008000, v223
v_accvgpr_write_b32 a244, v220
v_accvgpr_write_b32 a245, v221
v_accvgpr_write_b32 a246, v222
v_accvgpr_write_b32 a247, v223
v_xor_b32 v220, v199, v220
v_xor_b32 v221, v199, v221
v_xor_b32 v222, v199, v222
v_xor_b32 v223, v199, v223
v_accvgpr_write_b32 a240, v220
v_accvgpr_write_b32 a241, v221
v_accvgpr_write_b32 a242, v222
v_accvgpr_write_b32 a243, v223
v_mul_f32 v196, 0x3d000000, v196
v_mov_b32 v197, v198
v_cos_f32 v192, v196
s_nop 0
v_add_f32 v192, v192, v192
v_add_f32 v57, v197, v196
v_cos_f32 v48, v197
v_sin_f32 v56, v197
v_cos_f32 v49, v57
v_sin_f32 v57, v57
v_fma_f32 v50, v192, v49, -v48
v_fma_f32 v58, v192, v57, -v56
v_fma_f32 v51, v192, v50, -v49
v_fma_f32 v59, v192, v58, -v57
v_fma_f32 v52, v192, v51, -v50
v_fma_f32 v60, v192, v59, -v58
v_fma_f32 v53, v192, v52, -v51
v_fma_f32 v61, v192, v60, -v59
v_fma_f32 v54, v192, v53, -v52
v_fma_f32 v62, v192, v61, -v60
v_fma_f32 v55, v192, v54, -v53
v_fma_f32 v63, v192, v62, -v61
v_cvt_f32_u32 v198, s32
v_fma_f32 v198, v198, 4.0, v193
v_mul_f32 v198, 4.0, v198
v_mul_f32 v193, 0x41000000, v193
v_mul_f32 v196, 0x3d000000, v195
v_mul_f32 v197, v193, v196
v_cos_f32 v192, v196
s_nop 0
v_add_f32 v192, v192, v192
v_add_f32 v209, v197, v196
v_cos_f32 v200, v197
v_sin_f32 v208, v197
v_cos_f32 v201, v209
v_sin_f32 v209, v209
v_fma_f32 v202, v192, v201, -v200
v_fma_f32 v210, v192, v209, -v208
v_fma_f32 v203, v192, v202, -v201
v_fma_f32 v211, v192, v210, -v209
v_fma_f32 v204, v192, v203, -v202
v_fma_f32 v212, v192, v211, -v210
v_fma_f32 v205, v192, v204, -v203
v_fma_f32 v213, v192, v212, -v211
v_fma_f32 v206, v192, v205, -v204
v_fma_f32 v214, v192, v213, -v212
v_fma_f32 v207, v192, v206, -v205
v_fma_f32 v215, v192, v214, -v213
v_cvt_pk_bf16_f32 v216, v200, v201
v_cvt_pk_bf16_f32 v217, v202, v203
v_cvt_pk_bf16_f32 v218, v204, v205
v_cvt_pk_bf16_f32 v219, v206, v207
v_cvt_pk_bf16_f32 v224, v208, v209
v_cvt_pk_bf16_f32 v225, v210, v211
v_cvt_pk_bf16_f32 v226, v212, v213
v_cvt_pk_bf16_f32 v227, v214, v215
v_accvgpr_write_b32 a248, v216
v_accvgpr_write_b32 a249, v217
v_accvgpr_write_b32 a250, v218
v_accvgpr_write_b32 a251, v219
v_mul_f32 v196, 0x3c800000, v196
v_mul_f32 v197, v198, v196
v_cos_f32 v192, v196
s_nop 0
v_add_f32 v192, v192, v192
v_add_f32 v73, v197, v196
v_cos_f32 v64, v197
v_sin_f32 v72, v197
v_cos_f32 v65, v73
v_sin_f32 v73, v73
v_mul_f32 v64, s71, v64
v_mul_f32 v72, s71, v72
v_mul_f32 v65, s71, v65
v_mul_f32 v73, s71, v73
v_fma_f32 v66, v192, v65, -v64
v_fma_f32 v74, v192, v73, -v72
v_fma_f32 v67, v192, v66, -v65
v_fma_f32 v75, v192, v74, -v73
v_add_f32 v195, 4.0, v195
v_mul_f32 v196, 0x3d000000, v195
v_mul_f32 v197, v193, v196
v_cos_f32 v192, v196
s_nop 0
v_add_f32 v192, v192, v192
v_add_f32 v209, v197, v196
v_cos_f32 v200, v197
v_sin_f32 v208, v197
v_cos_f32 v201, v209
v_sin_f32 v209, v209
v_fma_f32 v202, v192, v201, -v200
v_fma_f32 v210, v192, v209, -v208
v_fma_f32 v203, v192, v202, -v201
v_fma_f32 v211, v192, v210, -v209
v_fma_f32 v204, v192, v203, -v202
v_fma_f32 v212, v192, v211, -v210
v_fma_f32 v205, v192, v204, -v203
v_fma_f32 v213, v192, v212, -v211
v_fma_f32 v206, v192, v205, -v204
v_fma_f32 v214, v192, v213, -v212
v_fma_f32 v207, v192, v206, -v205
v_fma_f32 v215, v192, v214, -v213
v_cvt_pk_bf16_f32 v216, v200, v201
v_cvt_pk_bf16_f32 v217, v202, v203
v_cvt_pk_bf16_f32 v218, v204, v205
v_cvt_pk_bf16_f32 v219, v206, v207
v_cvt_pk_bf16_f32 v228, v208, v209
v_cvt_pk_bf16_f32 v229, v210, v211
v_cvt_pk_bf16_f32 v230, v212, v213
v_cvt_pk_bf16_f32 v231, v214, v215
v_accvgpr_write_b32 a252, v216
v_accvgpr_write_b32 a253, v217
v_accvgpr_write_b32 a254, v218
v_accvgpr_write_b32 a255, v219
v_mul_f32 v196, 0x3c800000, v196
v_mul_f32 v197, v198, v196
v_cos_f32 v192, v196
s_nop 0
v_add_f32 v192, v192, v192
v_add_f32 v77, v197, v196
v_cos_f32 v68, v197
v_sin_f32 v76, v197
v_cos_f32 v69, v77
v_sin_f32 v77, v77
v_mul_f32 v68, s71, v68
v_mul_f32 v76, s71, v76
v_mul_f32 v69, s71, v69
v_mul_f32 v77, s71, v77
v_fma_f32 v70, v192, v69, -v68
v_fma_f32 v78, v192, v77, -v76
v_fma_f32 v71, v192, v70, -v69
v_fma_f32 v79, v192, v78, -v77
L_aux1:
s_waitcnt vmcnt(5)
s_barrier
ds_read_u16 v160, v9 offset:0
ds_read_u16 v161, v9 offset:4480
ds_read_u16 v162, v9 offset:8960
ds_read_u16 v163, v9 offset:13440
ds_read_u16 v164, v9 offset:17920
ds_read_u16 v165, v9 offset:22400
ds_read_u16 v166, v9 offset:26880
ds_read_u16 v167, v9 offset:31360
ds_read_u16 v168, v17 offset:0
ds_read_u16 v169, v17 offset:4480
ds_read_u16 v170, v17 offset:8960
ds_read_u16 v171, v17 offset:13440
ds_read_u16 v172, v17 offset:17920
ds_read_u16 v173, v17 offset:22400
s_waitcnt lgkmcnt(6)
ds_read_u16 v174, v17 offset:26880
ds_read_u16 v175, v17 offset:31360
v_lshl_or_b32 v176, v161, 16, v160
v_lshl_or_b32 v177, v163, 16, v162
v_lshl_or_b32 v178, v165, 16, v164
v_lshl_or_b32 v179, v167, 16, v166
buffer_store_dwordx4 v[176:179], v10, s[20:23], s41 offen sc1
s_add_u32 s41, s41, 262144
ds_read_u16 v160, v9 offset:64
ds_read_u16 v161, v9 offset:4544
ds_read_u16 v162, v9 offset:9024
ds_read_u16 v163, v9 offset:13504
ds_read_u16 v164, v9 offset:17984
ds_read_u16 v165, v9 offset:22464
s_waitcnt lgkmcnt(6)
ds_read_u16 v166, v9 offset:26944
ds_read_u16 v167, v9 offset:31424
v_lshl_or_b32 v180, v169, 16, v168
v_lshl_or_b32 v181, v171, 16, v170
v_lshl_or_b32 v182, v173, 16, v172
v_lshl_or_b32 v183, v175, 16, v174
buffer_store_dwordx4 v[180:183], v10, s[20:23], s42 offen sc1
s_add_u32 s42, s42, 262144
ds_read_u16 v168, v17 offset:64
ds_read_u16 v169, v17 offset:4544
ds_read_u16 v170, v17 offset:9024
ds_read_u16 v171, v17 offset:13504
ds_read_u16 v172, v17 offset:17984
ds_read_u16 v173, v17 offset:22464
s_waitcnt lgkmcnt(6)
ds_read_u16 v174, v17 offset:26944
ds_read_u16 v175, v17 offset:31424
v_lshl_or_b32 v176, v161, 16, v160
v_lshl_or_b32 v177, v163, 16, v162
v_lshl_or_b32 v178, v165, 16, v164
v_lshl_or_b32 v179, v167, 16, v166
buffer_store_dwordx4 v[176:179], v10, s[20:23], s41 offen sc1
s_add_u32 s41, s41, 262144
ds_read_u16 v160, v9 offset:128
ds_read_u16 v161, v9 offset:4608
ds_read_u16 v162, v9 offset:9088
ds_read_u16 v163, v9 offset:13568
ds_read_u16 v164, v9 offset:18048
ds_read_u16 v165, v9 offset:22528
s_waitcnt lgkmcnt(6)
ds_read_u16 v166, v9 offset:27008
ds_read_u16 v167, v9 offset:31488
v_lshl_or_b32 v180, v169, 16, v168
v_lshl_or_b32 v181, v171, 16, v170
v_lshl_or_b32 v182, v173, 16, v172
v_lshl_or_b32 v183, v175, 16, v174
buffer_store_dwordx4 v[180:183], v10, s[20:23], s42 offen sc1
s_add_u32 s42, s42, 262144
ds_read_u16 v168, v17 offset:128
ds_read_u16 v169, v17 offset:4608
ds_read_u16 v170, v17 offset:9088
ds_read_u16 v171, v17 offset:13568
ds_read_u16 v172, v17 offset:18048
ds_read_u16 v173, v17 offset:22528
s_waitcnt lgkmcnt(6)
ds_read_u16 v174, v17 offset:27008
ds_read_u16 v175, v17 offset:31488
v_lshl_or_b32 v176, v161, 16, v160
v_lshl_or_b32 v177, v163, 16, v162
v_lshl_or_b32 v178, v165, 16, v164
v_lshl_or_b32 v179, v167, 16, v166
buffer_store_dwordx4 v[176:179], v10, s[20:23], s41 offen sc1
s_add_u32 s41, s41, 262144
ds_read_u16 v160, v9 offset:192
ds_read_u16 v161, v9 offset:4672
ds_read_u16 v162, v9 offset:9152
ds_read_u16 v163, v9 offset:13632
ds_read_u16 v164, v9 offset:18112
ds_read_u16 v165, v9 offset:22592
s_waitcnt lgkmcnt(6)
ds_read_u16 v166, v9 offset:27072
ds_read_u16 v167, v9 offset:31552
v_lshl_or_b32 v180, v169, 16, v168
v_lshl_or_b32 v181, v171, 16, v170
v_lshl_or_b32 v182, v173, 16, v172
v_lshl_or_b32 v183, v175, 16, v174
buffer_store_dwordx4 v[180:183], v10, s[20:23], s42 offen sc1
s_add_u32 s42, s42, 262144
ds_read_u16 v168, v17 offset:192
ds_read_u16 v169, v17 offset:4672
ds_read_u16 v170, v17 offset:9152
ds_read_u16 v171, v17 offset:13632
ds_read_u16 v172, v17 offset:18112
ds_read_u16 v173, v17 offset:22592
s_waitcnt lgkmcnt(6)
ds_read_u16 v174, v17 offset:27072
ds_read_u16 v175, v17 offset:31552
v_lshl_or_b32 v176, v161, 16, v160
v_lshl_or_b32 v177, v163, 16, v162
v_lshl_or_b32 v178, v165, 16, v164
v_lshl_or_b32 v179, v167, 16, v166
buffer_store_dwordx4 v[176:179], v10, s[20:23], s41 offen sc1
s_add_u32 s41, s41, 262144
ds_read_u16 v160, v9 offset:256
ds_read_u16 v161, v9 offset:4736
ds_read_u16 v162, v9 offset:9216
ds_read_u16 v163, v9 offset:13696
ds_read_u16 v164, v9 offset:18176
ds_read_u16 v165, v9 offset:22656
s_waitcnt lgkmcnt(6)
ds_read_u16 v166, v9 offset:27136
ds_read_u16 v167, v9 offset:31616
v_lshl_or_b32 v180, v169, 16, v168
v_lshl_or_b32 v181, v171, 16, v170
v_lshl_or_b32 v182, v173, 16, v172
v_lshl_or_b32 v183, v175, 16, v174
buffer_store_dwordx4 v[180:183], v10, s[20:23], s42 offen sc1
s_add_u32 s42, s42, 262144
ds_read_u16 v168, v17 offset:256
ds_read_u16 v169, v17 offset:4736
ds_read_u16 v170, v17 offset:9216
ds_read_u16 v171, v17 offset:13696
ds_read_u16 v172, v17 offset:18176
ds_read_u16 v173, v17 offset:22656
s_waitcnt lgkmcnt(6)
ds_read_u16 v174, v17 offset:27136
ds_read_u16 v175, v17 offset:31616
v_lshl_or_b32 v176, v161, 16, v160
v_lshl_or_b32 v177, v163, 16, v162
v_lshl_or_b32 v178, v165, 16, v164
v_lshl_or_b32 v179, v167, 16, v166
buffer_store_dwordx4 v[176:179], v10, s[20:23], s41 offen sc1
s_add_u32 s41, s41, 262144
ds_read_u16 v160, v9 offset:320
ds_read_u16 v161, v9 offset:4800
ds_read_u16 v162, v9 offset:9280
ds_read_u16 v163, v9 offset:13760
ds_read_u16 v164, v9 offset:18240
ds_read_u16 v165, v9 offset:22720
s_waitcnt lgkmcnt(6)
ds_read_u16 v166, v9 offset:27200
ds_read_u16 v167, v9 offset:31680
v_lshl_or_b32 v180, v169, 16, v168
v_lshl_or_b32 v181, v171, 16, v170
v_lshl_or_b32 v182, v173, 16, v172
v_lshl_or_b32 v183, v175, 16, v174
buffer_store_dwordx4 v[180:183], v10, s[20:23], s42 offen sc1
s_add_u32 s42, s42, 262144
ds_read_u16 v168, v17 offset:320
ds_read_u16 v169, v17 offset:4800
ds_read_u16 v170, v17 offset:9280
ds_read_u16 v171, v17 offset:13760
ds_read_u16 v172, v17 offset:18240
ds_read_u16 v173, v17 offset:22720
s_waitcnt lgkmcnt(6)
ds_read_u16 v174, v17 offset:27200
ds_read_u16 v175, v17 offset:31680
v_lshl_or_b32 v176, v161, 16, v160
v_lshl_or_b32 v177, v163, 16, v162
v_lshl_or_b32 v178, v165, 16, v164
v_lshl_or_b32 v179, v167, 16, v166
buffer_store_dwordx4 v[176:179], v10, s[20:23], s41 offen sc1
s_add_u32 s41, s41, 262144
ds_read_u16 v160, v9 offset:384
ds_read_u16 v161, v9 offset:4864
ds_read_u16 v162, v9 offset:9344
ds_read_u16 v163, v9 offset:13824
ds_read_u16 v164, v9 offset:18304
ds_read_u16 v165, v9 offset:22784
s_waitcnt lgkmcnt(6)
ds_read_u16 v166, v9 offset:27264
ds_read_u16 v167, v9 offset:31744
v_lshl_or_b32 v180, v169, 16, v168
v_lshl_or_b32 v181, v171, 16, v170
v_lshl_or_b32 v182, v173, 16, v172
v_lshl_or_b32 v183, v175, 16, v174
buffer_store_dwordx4 v[180:183], v10, s[20:23], s42 offen sc1
s_add_u32 s42, s42, 262144
ds_read_u16 v168, v17 offset:384
ds_read_u16 v169, v17 offset:4864
ds_read_u16 v170, v17 offset:9344
ds_read_u16 v171, v17 offset:13824
ds_read_u16 v172, v17 offset:18304
ds_read_u16 v173, v17 offset:22784
s_waitcnt lgkmcnt(6)
ds_read_u16 v174, v17 offset:27264
ds_read_u16 v175, v17 offset:31744
v_lshl_or_b32 v176, v161, 16, v160
v_lshl_or_b32 v177, v163, 16, v162
v_lshl_or_b32 v178, v165, 16, v164
v_lshl_or_b32 v179, v167, 16, v166
buffer_store_dwordx4 v[176:179], v10, s[20:23], s41 offen sc1
s_add_u32 s41, s41, 262144
ds_read_u16 v160, v9 offset:448
ds_read_u16 v161, v9 offset:4928
ds_read_u16 v162, v9 offset:9408
ds_read_u16 v163, v9 offset:13888
ds_read_u16 v164, v9 offset:18368
ds_read_u16 v165, v9 offset:22848
s_waitcnt lgkmcnt(6)
ds_read_u16 v166, v9 offset:27328
ds_read_u16 v167, v9 offset:31808
v_lshl_or_b32 v180, v169, 16, v168
v_lshl_or_b32 v181, v171, 16, v170
v_lshl_or_b32 v182, v173, 16, v172
v_lshl_or_b32 v183, v175, 16, v174
buffer_store_dwordx4 v[180:183], v10, s[20:23], s42 offen sc1
s_add_u32 s42, s42, 262144
ds_read_u16 v168, v17 offset:448
ds_read_u16 v169, v17 offset:4928
ds_read_u16 v170, v17 offset:9408
ds_read_u16 v171, v17 offset:13888
ds_read_u16 v172, v17 offset:18368
ds_read_u16 v173, v17 offset:22848
v_cmp_gt_u32 vcc, 8192, v10
s_nop 1
v_cndmask_b32 v10, 2.0, v10, vcc
s_waitcnt lgkmcnt(6)
ds_read_u16 v174, v17 offset:27328
ds_read_u16 v175, v17 offset:31808
v_lshl_or_b32 v176, v161, 16, v160
v_lshl_or_b32 v177, v163, 16, v162
v_lshl_or_b32 v178, v165, 16, v164
v_lshl_or_b32 v179, v167, 16, v166
buffer_store_dwordx4 v[176:179], v10, s[20:23], s41 offen sc1
s_add_u32 s41, s41, 262144
s_waitcnt lgkmcnt(0)
v_lshl_or_b32 v180, v169, 16, v168
v_lshl_or_b32 v181, v171, 16, v170
v_lshl_or_b32 v182, v173, 16, v172
v_lshl_or_b32 v183, v175, 16, v174
buffer_store_dwordx4 v[180:183], v10, s[20:23], s42 offen sc1
s_add_u32 s42, s42, 262144
buffer_load_dword v28, v30, s[28:31], 0 offen sc1
s_waitcnt vmcnt(0)
v_cmp_ne_u32 vcc, 1, v28
s_cbranch_vccnz L_slow_goa
L_back_goa:
s_barrier
s_lshl_b32 s79, s35, 7
s_add_u32 s79, s79, 114688
s_cmp_lg_u32 s32, 0
s_cselect_b32 s42, 1073741824, 0
v_mov_b32 v16, s42
s_mov_b64 exec, 1
buffer_store_dword v28, v16, s[20:23], s79 offen sc1
s_mov_b64 exec, -1
buffer_load_dwordx4 v[160:163], v3, s[4:7], 0 offen offset:0
buffer_load_dwordx4 v[96:99], v8, s[56:59], 0 offen offset:0
buffer_load_dwordx4 v[164:167], v3, s[4:7], 0 offen offset:64
buffer_load_dwordx4 v[100:103], v8, s[56:59], 0 offen offset:64
buffer_load_dwordx4 v[168:171], v3, s[4:7], 0 offen offset:128
buffer_load_dwordx4 v[104:107], v8, s[56:59], 0 offen offset:128
buffer_load_dwordx4 v[172:175], v3, s[4:7], 0 offen offset:192
buffer_load_dwordx4 v[108:111], v8, s[56:59], 0 offen offset:192
buffer_load_dwordx4 v[176:179], v3, s[4:7], 0 offen offset:256
buffer_load_dwordx4 v[112:115], v8, s[56:59], 0 offen offset:256
buffer_load_dwordx4 v[180:183], v3, s[4:7], 0 offen offset:320
buffer_load_dwordx4 v[116:119], v8, s[56:59], 0 offen offset:320
buffer_load_dwordx4 v[184:187], v3, s[4:7], 0 offen offset:384
buffer_load_dwordx4 v[120:123], v8, s[56:59], 0 offen offset:384
buffer_load_dwordx4 v[188:191], v3, s[4:7], 0 offen offset:448
buffer_load_dwordx4 v[124:127], v8, s[56:59], 0 offen offset:448
buffer_load_dwordx4 v[192:195], v3, s[4:7], 0 offen offset:512
buffer_load_dwordx4 v[128:131], v8, s[56:59], 0 offen offset:512
buffer_load_dwordx4 v[196:199], v3, s[4:7], 0 offen offset:576
buffer_load_dwordx4 v[132:135], v8, s[56:59], 0 offen offset:576
buffer_load_dwordx4 v[200:203], v3, s[4:7], 0 offen offset:640
buffer_load_dwordx4 v[136:139], v8, s[56:59], 0 offen offset:640
buffer_load_dwordx4 v[204:207], v3, s[4:7], 0 offen offset:704
buffer_load_dwordx4 v[140:143], v8, s[56:59], 0 offen offset:704
buffer_load_dwordx4 v[208:211], v3, s[4:7], 0 offen offset:768
buffer_load_dwordx4 v[144:147], v8, s[56:59], 0 offen offset:768
buffer_load_dwordx4 v[212:215], v3, s[4:7], 0 offen offset:832
buffer_load_dwordx4 v[148:151], v8, s[56:59], 0 offen offset:832
v_mov_b32 v4, 0
v_mov_b32 v5, 0
v_mov_b32 v6, 0
v_mov_b32 v7, 0
s_mov_b32 s42, 0x3f803f80
s_waitcnt vmcnt(26)
v_lshlrev_b32 v32, 16, v160
v_and_b32 v33, 0xffff0000, v160
v_lshlrev_b32 v34, 16, v96
v_and_b32 v35, 0xffff0000, v96
v_lshlrev_b32 v36, 16, v161
v_and_b32 v37, 0xffff0000, v161
v_lshlrev_b32 v38, 16, v97
v_and_b32 v39, 0xffff0000, v97
v_lshlrev_b32 v40, 16, v162
v_and_b32 v41, 0xffff0000, v162
v_lshlrev_b32 v42, 16, v98
v_and_b32 v43, 0xffff0000, v98
v_lshlrev_b32 v44, 16, v163
v_and_b32 v45, 0xffff0000, v163
v_lshlrev_b32 v46, 16, v99
v_and_b32 v47, 0xffff0000, v99
v_pk_mul_f32 v[32:33], v[32:33], v[34:35]
v_pk_mul_f32 v[36:37], v[36:37], v[38:39]
v_pk_mul_f32 v[40:41], v[40:41], v[42:43]
v_pk_mul_f32 v[44:45], v[44:45], v[46:47]
v_cvt_pk_bf16_f32 v32, v32, v33
v_cvt_pk_bf16_f32 v36, v36, v37
v_cvt_pk_bf16_f32 v40, v40, v41
v_cvt_pk_bf16_f32 v44, v44, v45
v_dot2_f32_bf16 v4, v32, s42, v4
v_dot2_f32_bf16 v5, v36, s42, v5
v_dot2_f32_bf16 v6, v40, s42, v6
v_dot2_f32_bf16 v7, v44, s42, v7
s_waitcnt vmcnt(24)
v_lshlrev_b32 v32, 16, v164
v_and_b32 v33, 0xffff0000, v164
v_lshlrev_b32 v34, 16, v100
v_and_b32 v35, 0xffff0000, v100
v_lshlrev_b32 v36, 16, v165
v_and_b32 v37, 0xffff0000, v165
v_lshlrev_b32 v38, 16, v101
v_and_b32 v39, 0xffff0000, v101
v_lshlrev_b32 v40, 16, v166
v_and_b32 v41, 0xffff0000, v166
v_lshlrev_b32 v42, 16, v102
v_and_b32 v43, 0xffff0000, v102
v_lshlrev_b32 v44, 16, v167
v_and_b32 v45, 0xffff0000, v167
v_lshlrev_b32 v46, 16, v103
v_and_b32 v47, 0xffff0000, v103
v_pk_mul_f32 v[32:33], v[32:33], v[34:35]
v_pk_mul_f32 v[36:37], v[36:37], v[38:39]
v_pk_mul_f32 v[40:41], v[40:41], v[42:43]
v_pk_mul_f32 v[44:45], v[44:45], v[46:47]
v_cvt_pk_bf16_f32 v32, v32, v33
v_cvt_pk_bf16_f32 v36, v36, v37
v_cvt_pk_bf16_f32 v40, v40, v41
v_cvt_pk_bf16_f32 v44, v44, v45
v_dot2_f32_bf16 v4, v32, s42, v4
v_dot2_f32_bf16 v5, v36, s42, v5
v_dot2_f32_bf16 v6, v40, s42, v6
v_dot2_f32_bf16 v7, v44, s42, v7
s_waitcnt vmcnt(22)
v_lshlrev_b32 v32, 16, v168
v_and_b32 v33, 0xffff0000, v168
v_lshlrev_b32 v34, 16, v104
v_and_b32 v35, 0xffff0000, v104
v_lshlrev_b32 v36, 16, v169
v_and_b32 v37, 0xffff0000, v169
v_lshlrev_b32 v38, 16, v105
v_and_b32 v39, 0xffff0000, v105
v_lshlrev_b32 v40, 16, v170
v_and_b32 v41, 0xffff0000, v170
v_lshlrev_b32 v42, 16, v106
v_and_b32 v43, 0xffff0000, v106
v_lshlrev_b32 v44, 16, v171
v_and_b32 v45, 0xffff0000, v171
v_lshlrev_b32 v46, 16, v107
v_and_b32 v47, 0xffff0000, v107
v_pk_mul_f32 v[32:33], v[32:33], v[34:35]
v_pk_mul_f32 v[36:37], v[36:37], v[38:39]
v_pk_mul_f32 v[40:41], v[40:41], v[42:43]
v_pk_mul_f32 v[44:45], v[44:45], v[46:47]
v_cvt_pk_bf16_f32 v32, v32, v33
v_cvt_pk_bf16_f32 v36, v36, v37
v_cvt_pk_bf16_f32 v40, v40, v41
v_cvt_pk_bf16_f32 v44, v44, v45
v_dot2_f32_bf16 v4, v32, s42, v4
v_dot2_f32_bf16 v5, v36, s42, v5
v_dot2_f32_bf16 v6, v40, s42, v6
v_dot2_f32_bf16 v7, v44, s42, v7
s_waitcnt vmcnt(20)
v_lshlrev_b32 v32, 16, v172
v_and_b32 v33, 0xffff0000, v172
v_lshlrev_b32 v34, 16, v108
v_and_b32 v35, 0xffff0000, v108
v_lshlrev_b32 v36, 16, v173
v_and_b32 v37, 0xffff0000, v173
v_lshlrev_b32 v38, 16, v109
v_and_b32 v39, 0xffff0000, v109
v_lshlrev_b32 v40, 16, v174
v_and_b32 v41, 0xffff0000, v174
v_lshlrev_b32 v42, 16, v110
v_and_b32 v43, 0xffff0000, v110
v_lshlrev_b32 v44, 16, v175
v_and_b32 v45, 0xffff0000, v175
v_lshlrev_b32 v46, 16, v111
v_and_b32 v47, 0xffff0000, v111
v_pk_mul_f32 v[32:33], v[32:33], v[34:35]
v_pk_mul_f32 v[36:37], v[36:37], v[38:39]
v_pk_mul_f32 v[40:41], v[40:41], v[42:43]
v_pk_mul_f32 v[44:45], v[44:45], v[46:47]
v_cvt_pk_bf16_f32 v32, v32, v33
v_cvt_pk_bf16_f32 v36, v36, v37
v_cvt_pk_bf16_f32 v40, v40, v41
v_cvt_pk_bf16_f32 v44, v44, v45
v_dot2_f32_bf16 v4, v32, s42, v4
v_dot2_f32_bf16 v5, v36, s42, v5
v_dot2_f32_bf16 v6, v40, s42, v6
v_dot2_f32_bf16 v7, v44, s42, v7
s_waitcnt vmcnt(18)
v_lshlrev_b32 v32, 16, v176
v_and_b32 v33, 0xffff0000, v176
v_lshlrev_b32 v34, 16, v112
v_and_b32 v35, 0xffff0000, v112
v_lshlrev_b32 v36, 16, v177
v_and_b32 v37, 0xffff0000, v177
v_lshlrev_b32 v38, 16, v113
v_and_b32 v39, 0xffff0000, v113
v_lshlrev_b32 v40, 16, v178
v_and_b32 v41, 0xffff0000, v178
v_lshlrev_b32 v42, 16, v114
v_and_b32 v43, 0xffff0000, v114
v_lshlrev_b32 v44, 16, v179
v_and_b32 v45, 0xffff0000, v179
v_lshlrev_b32 v46, 16, v115
v_and_b32 v47, 0xffff0000, v115
v_pk_mul_f32 v[32:33], v[32:33], v[34:35]
v_pk_mul_f32 v[36:37], v[36:37], v[38:39]
v_pk_mul_f32 v[40:41], v[40:41], v[42:43]
v_pk_mul_f32 v[44:45], v[44:45], v[46:47]
v_cvt_pk_bf16_f32 v32, v32, v33
v_cvt_pk_bf16_f32 v36, v36, v37
v_cvt_pk_bf16_f32 v40, v40, v41
v_cvt_pk_bf16_f32 v44, v44, v45
v_dot2_f32_bf16 v4, v32, s42, v4
v_dot2_f32_bf16 v5, v36, s42, v5
v_dot2_f32_bf16 v6, v40, s42, v6
v_dot2_f32_bf16 v7, v44, s42, v7
s_waitcnt vmcnt(16)
v_lshlrev_b32 v32, 16, v180
v_and_b32 v33, 0xffff0000, v180
v_lshlrev_b32 v34, 16, v116
v_and_b32 v35, 0xffff0000, v116
v_lshlrev_b32 v36, 16, v181
v_and_b32 v37, 0xffff0000, v181
v_lshlrev_b32 v38, 16, v117
v_and_b32 v39, 0xffff0000, v117
v_lshlrev_b32 v40, 16, v182
v_and_b32 v41, 0xffff0000, v182
v_lshlrev_b32 v42, 16, v118
v_and_b32 v43, 0xffff0000, v118
v_lshlrev_b32 v44, 16, v183
v_and_b32 v45, 0xffff0000, v183
v_lshlrev_b32 v46, 16, v119
v_and_b32 v47, 0xffff0000, v119
v_pk_mul_f32 v[32:33], v[32:33], v[34:35]
v_pk_mul_f32 v[36:37], v[36:37], v[38:39]
v_pk_mul_f32 v[40:41], v[40:41], v[42:43]
v_pk_mul_f32 v[44:45], v[44:45], v[46:47]
v_cvt_pk_bf16_f32 v32, v32, v33
v_cvt_pk_bf16_f32 v36, v36, v37
v_cvt_pk_bf16_f32 v40, v40, v41
v_cvt_pk_bf16_f32 v44, v44, v45
v_dot2_f32_bf16 v4, v32, s42, v4
v_dot2_f32_bf16 v5, v36, s42, v5
v_dot2_f32_bf16 v6, v40, s42, v6
v_dot2_f32_bf16 v7, v44, s42, v7
s_waitcnt vmcnt(14)
v_lshlrev_b32 v32, 16, v184
v_and_b32 v33, 0xffff0000, v184
v_lshlrev_b32 v34, 16, v120
v_and_b32 v35, 0xffff0000, v120
v_lshlrev_b32 v36, 16, v185
v_and_b32 v37, 0xffff0000, v185
v_lshlrev_b32 v38, 16, v121
v_and_b32 v39, 0xffff0000, v121
v_lshlrev_b32 v40, 16, v186
v_and_b32 v41, 0xffff0000, v186
v_lshlrev_b32 v42, 16, v122
v_and_b32 v43, 0xffff0000, v122
v_lshlrev_b32 v44, 16, v187
v_and_b32 v45, 0xffff0000, v187
v_lshlrev_b32 v46, 16, v123
v_and_b32 v47, 0xffff0000, v123
v_pk_mul_f32 v[32:33], v[32:33], v[34:35]
v_pk_mul_f32 v[36:37], v[36:37], v[38:39]
v_pk_mul_f32 v[40:41], v[40:41], v[42:43]
v_pk_mul_f32 v[44:45], v[44:45], v[46:47]
v_cvt_pk_bf16_f32 v32, v32, v33
v_cvt_pk_bf16_f32 v36, v36, v37
v_cvt_pk_bf16_f32 v40, v40, v41
v_cvt_pk_bf16_f32 v44, v44, v45
v_dot2_f32_bf16 v4, v32, s42, v4
v_dot2_f32_bf16 v5, v36, s42, v5
v_dot2_f32_bf16 v6, v40, s42, v6
v_dot2_f32_bf16 v7, v44, s42, v7
s_waitcnt vmcnt(12)
v_lshlrev_b32 v32, 16, v188
v_and_b32 v33, 0xffff0000, v188
v_lshlrev_b32 v34, 16, v124
v_and_b32 v35, 0xffff0000, v124
v_lshlrev_b32 v36, 16, v189
v_and_b32 v37, 0xffff0000, v189
v_lshlrev_b32 v38, 16, v125
v_and_b32 v39, 0xffff0000, v125
v_lshlrev_b32 v40, 16, v190
v_and_b32 v41, 0xffff0000, v190
v_lshlrev_b32 v42, 16, v126
v_and_b32 v43, 0xffff0000, v126
v_lshlrev_b32 v44, 16, v191
v_and_b32 v45, 0xffff0000, v191
v_lshlrev_b32 v46, 16, v127
v_and_b32 v47, 0xffff0000, v127
v_pk_mul_f32 v[32:33], v[32:33], v[34:35]
v_pk_mul_f32 v[36:37], v[36:37], v[38:39]
v_pk_mul_f32 v[40:41], v[40:41], v[42:43]
v_pk_mul_f32 v[44:45], v[44:45], v[46:47]
v_cvt_pk_bf16_f32 v32, v32, v33
v_cvt_pk_bf16_f32 v36, v36, v37
v_cvt_pk_bf16_f32 v40, v40, v41
v_cvt_pk_bf16_f32 v44, v44, v45
v_dot2_f32_bf16 v4, v32, s42, v4
v_dot2_f32_bf16 v5, v36, s42, v5
v_dot2_f32_bf16 v6, v40, s42, v6
v_dot2_f32_bf16 v7, v44, s42, v7
s_waitcnt vmcnt(10)
v_lshlrev_b32 v32, 16, v192
v_and_b32 v33, 0xffff0000, v192
v_lshlrev_b32 v34, 16, v128
v_and_b32 v35, 0xffff0000, v128
v_lshlrev_b32 v36, 16, v193
v_and_b32 v37, 0xffff0000, v193
v_lshlrev_b32 v38, 16, v129
v_and_b32 v39, 0xffff0000, v129
v_lshlrev_b32 v40, 16, v194
v_and_b32 v41, 0xffff0000, v194
v_lshlrev_b32 v42, 16, v130
v_and_b32 v43, 0xffff0000, v130
v_lshlrev_b32 v44, 16, v195
v_and_b32 v45, 0xffff0000, v195
v_lshlrev_b32 v46, 16, v131
v_and_b32 v47, 0xffff0000, v131
v_pk_mul_f32 v[32:33], v[32:33], v[34:35]
v_pk_mul_f32 v[36:37], v[36:37], v[38:39]
v_pk_mul_f32 v[40:41], v[40:41], v[42:43]
v_pk_mul_f32 v[44:45], v[44:45], v[46:47]
v_cvt_pk_bf16_f32 v32, v32, v33
v_cvt_pk_bf16_f32 v36, v36, v37
v_cvt_pk_bf16_f32 v40, v40, v41
v_cvt_pk_bf16_f32 v44, v44, v45
v_dot2_f32_bf16 v4, v32, s42, v4
v_dot2_f32_bf16 v5, v36, s42, v5
v_dot2_f32_bf16 v6, v40, s42, v6
v_dot2_f32_bf16 v7, v44, s42, v7
s_waitcnt vmcnt(8)
v_lshlrev_b32 v32, 16, v196
v_and_b32 v33, 0xffff0000, v196
v_lshlrev_b32 v34, 16, v132
v_and_b32 v35, 0xffff0000, v132
v_lshlrev_b32 v36, 16, v197
v_and_b32 v37, 0xffff0000, v197
v_lshlrev_b32 v38, 16, v133
v_and_b32 v39, 0xffff0000, v133
v_lshlrev_b32 v40, 16, v198
v_and_b32 v41, 0xffff0000, v198
v_lshlrev_b32 v42, 16, v134
v_and_b32 v43, 0xffff0000, v134
v_lshlrev_b32 v44, 16, v199
v_and_b32 v45, 0xffff0000, v199
v_lshlrev_b32 v46, 16, v135
v_and_b32 v47, 0xffff0000, v135
v_pk_mul_f32 v[32:33], v[32:33], v[34:35]
v_pk_mul_f32 v[36:37], v[36:37], v[38:39]
v_pk_mul_f32 v[40:41], v[40:41], v[42:43]
v_pk_mul_f32 v[44:45], v[44:45], v[46:47]
v_cvt_pk_bf16_f32 v32, v32, v33
v_cvt_pk_bf16_f32 v36, v36, v37
v_cvt_pk_bf16_f32 v40, v40, v41
v_cvt_pk_bf16_f32 v44, v44, v45
v_dot2_f32_bf16 v4, v32, s42, v4
v_dot2_f32_bf16 v5, v36, s42, v5
v_dot2_f32_bf16 v6, v40, s42, v6
v_dot2_f32_bf16 v7, v44, s42, v7
s_waitcnt vmcnt(6)
v_lshlrev_b32 v32, 16, v200
v_and_b32 v33, 0xffff0000, v200
v_lshlrev_b32 v34, 16, v136
v_and_b32 v35, 0xffff0000, v136
v_lshlrev_b32 v36, 16, v201
v_and_b32 v37, 0xffff0000, v201
v_lshlrev_b32 v38, 16, v137
v_and_b32 v39, 0xffff0000, v137
v_lshlrev_b32 v40, 16, v202
v_and_b32 v41, 0xffff0000, v202
v_lshlrev_b32 v42, 16, v138
v_and_b32 v43, 0xffff0000, v138
v_lshlrev_b32 v44, 16, v203
v_and_b32 v45, 0xffff0000, v203
v_lshlrev_b32 v46, 16, v139
v_and_b32 v47, 0xffff0000, v139
v_pk_mul_f32 v[32:33], v[32:33], v[34:35]
v_pk_mul_f32 v[36:37], v[36:37], v[38:39]
v_pk_mul_f32 v[40:41], v[40:41], v[42:43]
v_pk_mul_f32 v[44:45], v[44:45], v[46:47]
v_cvt_pk_bf16_f32 v32, v32, v33
v_cvt_pk_bf16_f32 v36, v36, v37
v_cvt_pk_bf16_f32 v40, v40, v41
v_cvt_pk_bf16_f32 v44, v44, v45
v_dot2_f32_bf16 v4, v32, s42, v4
v_dot2_f32_bf16 v5, v36, s42, v5
v_dot2_f32_bf16 v6, v40, s42, v6
v_dot2_f32_bf16 v7, v44, s42, v7
s_waitcnt vmcnt(4)
v_lshlrev_b32 v32, 16, v204
v_and_b32 v33, 0xffff0000, v204
v_lshlrev_b32 v34, 16, v140
v_and_b32 v35, 0xffff0000, v140
v_lshlrev_b32 v36, 16, v205
v_and_b32 v37, 0xffff0000, v205
v_lshlrev_b32 v38, 16, v141
v_and_b32 v39, 0xffff0000, v141
v_lshlrev_b32 v40, 16, v206
v_and_b32 v41, 0xffff0000, v206
v_lshlrev_b32 v42, 16, v142
v_and_b32 v43, 0xffff0000, v142
v_lshlrev_b32 v44, 16, v207
v_and_b32 v45, 0xffff0000, v207
v_lshlrev_b32 v46, 16, v143
v_and_b32 v47, 0xffff0000, v143
v_pk_mul_f32 v[32:33], v[32:33], v[34:35]
v_pk_mul_f32 v[36:37], v[36:37], v[38:39]
v_pk_mul_f32 v[40:41], v[40:41], v[42:43]
v_pk_mul_f32 v[44:45], v[44:45], v[46:47]
v_cvt_pk_bf16_f32 v32, v32, v33
v_cvt_pk_bf16_f32 v36, v36, v37
v_cvt_pk_bf16_f32 v40, v40, v41
v_cvt_pk_bf16_f32 v44, v44, v45
v_dot2_f32_bf16 v4, v32, s42, v4
v_dot2_f32_bf16 v5, v36, s42, v5
v_dot2_f32_bf16 v6, v40, s42, v6
v_dot2_f32_bf16 v7, v44, s42, v7
s_waitcnt vmcnt(2)
v_lshlrev_b32 v32, 16, v208
v_and_b32 v33, 0xffff0000, v208
v_lshlrev_b32 v34, 16, v144
v_and_b32 v35, 0xffff0000, v144
v_lshlrev_b32 v36, 16, v209
v_and_b32 v37, 0xffff0000, v209
v_lshlrev_b32 v38, 16, v145
v_and_b32 v39, 0xffff0000, v145
v_lshlrev_b32 v40, 16, v210
v_and_b32 v41, 0xffff0000, v210
v_lshlrev_b32 v42, 16, v146
v_and_b32 v43, 0xffff0000, v146
v_lshlrev_b32 v44, 16, v211
v_and_b32 v45, 0xffff0000, v211
v_lshlrev_b32 v46, 16, v147
v_and_b32 v47, 0xffff0000, v147
v_pk_mul_f32 v[32:33], v[32:33], v[34:35]
v_pk_mul_f32 v[36:37], v[36:37], v[38:39]
v_pk_mul_f32 v[40:41], v[40:41], v[42:43]
v_pk_mul_f32 v[44:45], v[44:45], v[46:47]
v_cvt_pk_bf16_f32 v32, v32, v33
v_cvt_pk_bf16_f32 v36, v36, v37
v_cvt_pk_bf16_f32 v40, v40, v41
v_cvt_pk_bf16_f32 v44, v44, v45
v_dot2_f32_bf16 v4, v32, s42, v4
v_dot2_f32_bf16 v5, v36, s42, v5
v_dot2_f32_bf16 v6, v40, s42, v6
v_dot2_f32_bf16 v7, v44, s42, v7
s_waitcnt vmcnt(0)
v_lshlrev_b32 v32, 16, v212
v_and_b32 v33, 0xffff0000, v212
v_lshlrev_b32 v34, 16, v148
v_and_b32 v35, 0xffff0000, v148
v_lshlrev_b32 v36, 16, v213
v_and_b32 v37, 0xffff0000, v213
v_lshlrev_b32 v38, 16, v149
v_and_b32 v39, 0xffff0000, v149
v_lshlrev_b32 v40, 16, v214
v_and_b32 v41, 0xffff0000, v214
v_lshlrev_b32 v42, 16, v150
v_and_b32 v43, 0xffff0000, v150
v_lshlrev_b32 v44, 16, v215
v_and_b32 v45, 0xffff0000, v215
v_lshlrev_b32 v46, 16, v151
v_and_b32 v47, 0xffff0000, v151
v_pk_mul_f32 v[32:33], v[32:33], v[34:35]
v_pk_mul_f32 v[36:37], v[36:37], v[38:39]
v_pk_mul_f32 v[40:41], v[40:41], v[42:43]
v_pk_mul_f32 v[44:45], v[44:45], v[46:47]
v_cvt_pk_bf16_f32 v32, v32, v33
v_cvt_pk_bf16_f32 v36, v36, v37
v_cvt_pk_bf16_f32 v40, v40, v41
v_cvt_pk_bf16_f32 v44, v44, v45
v_dot2_f32_bf16 v4, v32, s42, v4
v_dot2_f32_bf16 v5, v36, s42, v5
v_dot2_f32_bf16 v6, v40, s42, v6
v_dot2_f32_bf16 v7, v44, s42, v7
s_nop 0
v_add_f32 v4, v4, v5
s_nop 0
v_add_f32 v6, v6, v7
v_add_f32 v4, v4, v6
s_nop 1
v_add_f32_dpp v4, v4, v4 quad_perm:[1,0,3,2] row_mask:0xf bank_mask:0xf
s_nop 1
v_add_f32_dpp v4, v4, v4 quad_perm:[2,3,0,1] row_mask:0xf bank_mask:0xf
v_cvt_pk_bf16_f32 v4, 0, v4
v_mul_f32 v4, s44, v4
v_exp_f32 v4, v4
s_nop 0
v_add_f32 v4, 1.0, v4
v_rcp_f32 v4, v4
v_and_b32 v5, 60, v0
v_cvt_pk_bf16_f32 v4, 0, v4
v_max_u32 v4, 1, v4
s_lshl_b32 s41, s35, 2
s_add_u32 s41, s41, s32
s_lshl_b32 s41, s41, 6
s_add_u32 s41, s41, 253952
buffer_store_dword v4, v5, s[20:23], s41 offen sc1
s_cmp_lg_u32 s35, 4
s_cbranch_scc1 L_aux2
buffer_load_dword v29, v27, s[20:23], 0 offen sc1
s_lshl_b32 s41, s37, 13
s_lshl_b32 s40, s32, 10
s_add_u32 s42, s41, s40
s_cmp_eq_u32 s37, 224
s_cselect_b32 s48, 4096, s41
s_cselect_b32 s41, 0, s41
s_cselect_b32 s49, 16, 0
s_cmp_eq_u32 s41, 0
s_cselect_b32 s43, 1073741824, 0
s_add_u32 s48, s48, s40
s_lshl_b32 s40, s40, 1
s_add_u32 s41, s41, s40
s_add_u32 s41, s41, 1048576
s_add_u32 s42, s42, 4718592
s_add_u32 s48, s48, 2883584
v_xor_b32 v244, s49, v1
v_and_or_b32 v245, v245, s43, v244
v_or_b32 v244, s43, v1
v_add_u32 v244, 0x1000, v244
s_waitcnt vmcnt(0)
v_cmp_ne_u32 vcc, 1, v29
s_cbranch_vccnz L_slow_p1a
L_back_p1a:
s_add_u32 m0, s40, 148736
s_nop 0
buffer_load_dwordx4 v245, s[20:23], s41 offen sc1 lds
buffer_load_dwordx4 v245, s[20:23], s41 offen offset:1024 sc1 lds
buffer_load_dwordx4 v[232:235], v1, s[20:23], s42 offen sc1
s_add_u32 s42, s42, 4096
buffer_load_dwordx4 v[236:239], v1, s[20:23], s42 offen sc1
s_waitcnt vmcnt(2)
s_barrier
ds_read_b64_tr_b16 v[128:129], v240 offset:0
ds_read_b64_tr_b16 v[130:131], v240 offset:2048
ds_read_b64_tr_b16 v[136:137], v242 offset:0
ds_read_b64_tr_b16 v[138:139], v242 offset:2048
ds_read_b64_tr_b16 v[144:145], v241 offset:0
ds_read_b64_tr_b16 v[146:147], v241 offset:2048
ds_read_b64_tr_b16 v[152:153], v243 offset:0
ds_read_b64_tr_b16 v[154:155], v243 offset:2048
ds_read_b64_tr_b16 v[132:133], v240 offset:4096
ds_read_b64_tr_b16 v[134:135], v240 offset:6144
ds_read_b64_tr_b16 v[140:141], v242 offset:4096
ds_read_b64_tr_b16 v[142:143], v242 offset:6144
ds_read_b64_tr_b16 v[148:149], v241 offset:4096
ds_read_b64_tr_b16 v[150:151], v241 offset:6144
ds_read_b64_tr_b16 v[156:157], v243 offset:4096
s_waitcnt lgkmcnt(10)
ds_read_b64_tr_b16 v[158:159], v243 offset:6144
v_mfma_f32_16x16x32_bf16 v[96:99], v[128:131], a[224:227], 0
v_mfma_f32_16x16x32_bf16 v[104:107], v[128:131], a[240:243], 0
v_mfma_f32_16x16x32_bf16 v[100:103], v[136:139], a[224:227], 0
v_mfma_f32_16x16x32_bf16 v[108:111], v[136:139], a[240:243], 0
s_waitcnt lgkmcnt(10)
v_mfma_f32_16x16x32_bf16 v[96:99], v[144:147], a[232:235], v[96:99]
v_mfma_f32_16x16x32_bf16 v[104:107], v[144:147], a[224:227], v[104:107]
s_waitcnt lgkmcnt(8)
v_mfma_f32_16x16x32_bf16 v[100:103], v[152:155], a[232:235], v[100:103]
v_mfma_f32_16x16x32_bf16 v[108:111], v[152:155], a[224:227], v[108:111]
s_waitcnt lgkmcnt(6)
v_mfma_f32_16x16x32_bf16 v[96:99], v[132:135], a[228:231], v[96:99]
v_mfma_f32_16x16x32_bf16 v[104:107], v[132:135], a[244:247], v[104:107]
s_waitcnt lgkmcnt(4)
v_mfma_f32_16x16x32_bf16 v[100:103], v[140:143], a[228:231], v[100:103]
v_mfma_f32_16x16x32_bf16 v[108:111], v[140:143], a[244:247], v[108:111]
s_waitcnt lgkmcnt(2)
v_mfma_f32_16x16x32_bf16 v[96:99], v[148:151], a[236:239], v[96:99]
v_mfma_f32_16x16x32_bf16 v[104:107], v[148:151], a[228:231], v[104:107]
s_waitcnt lgkmcnt(0)
v_mfma_f32_16x16x32_bf16 v[100:103], v[156:159], a[236:239], v[100:103]
v_mfma_f32_16x16x32_bf16 v[108:111], v[156:159], a[228:231], v[108:111]
s_waitcnt vmcnt(0)
v_lshlrev_b32 v32, 16, v232
v_and_b32 v33, 0xffff0000, v232
v_lshlrev_b32 v34, 16, v233
v_and_b32 v35, 0xffff0000, v233
v_lshlrev_b32 v36, 16, v234
v_and_b32 v37, 0xffff0000, v234
v_lshlrev_b32 v38, 16, v235
v_and_b32 v39, 0xffff0000, v235
v_pk_mul_f32 v[120:121], v[96:97], v[56:57]
v_pk_mul_f32 v[112:113], v[104:105], v[56:57]
v_pk_mul_f32 v[122:123], v[98:99], v[58:59]
v_pk_mul_f32 v[114:115], v[106:107], v[58:59]
v_pk_mul_f32 v[124:125], v[100:101], v[60:61]
v_pk_mul_f32 v[116:117], v[108:109], v[60:61]
v_pk_mul_f32 v[126:127], v[102:103], v[62:63]
v_pk_mul_f32 v[118:119], v[110:111], v[62:63]
v_pk_fma_f32 v[112:113], v[96:97], v[48:49], v[112:113]
v_pk_fma_f32 v[120:121], v[104:105], v[48:49], v[120:121] neg_lo:[0,0,1] neg_hi:[0,0,1]
v_pk_fma_f32 v[114:115], v[98:99], v[50:51], v[114:115]
v_pk_fma_f32 v[122:123], v[106:107], v[50:51], v[122:123] neg_lo:[0,0,1] neg_hi:[0,0,1]
v_pk_fma_f32 v[116:117], v[100:101], v[52:53], v[116:117]
v_pk_fma_f32 v[124:125], v[108:109], v[52:53], v[124:125] neg_lo:[0,0,1] neg_hi:[0,0,1]
v_pk_fma_f32 v[118:119], v[102:103], v[54:55], v[118:119]
v_pk_fma_f32 v[126:127], v[110:111], v[54:55], v[126:127] neg_lo:[0,0,1] neg_hi:[0,0,1]
v_cvt_pk_bf16_f32 v80, v112, v113
v_cvt_pk_bf16_f32 v81, v114, v115
v_cvt_pk_bf16_f32 v82, v116, v117
v_cvt_pk_bf16_f32 v83, v118, v119
v_cvt_pk_bf16_f32 v84, v120, v121
v_cvt_pk_bf16_f32 v85, v122, v123
v_cvt_pk_bf16_f32 v86, v124, v125
v_cvt_pk_bf16_f32 v87, v126, v127
v_mfma_f32_16x16x32_bf16 v[96:99], a[248:251], v[80:83], 0
v_xor_b32 v88, 0x80008000, v80
v_xor_b32 v89, 0x80008000, v81
v_mfma_f32_16x16x32_bf16 v[100:103], a[252:255], v[80:83], 0
v_xor_b32 v90, 0x80008000, v82
v_xor_b32 v91, 0x80008000, v83
v_mfma_f32_16x16x32_bf16 v[104:107], a[248:251], v[84:87], 0
v_mfma_f32_16x16x32_bf16 v[108:111], a[252:255], v[84:87], 0
v_mfma_f32_16x16x32_bf16 v[96:99], v[224:227], v[84:87], v[96:99]
v_mfma_f32_16x16x32_bf16 v[100:103], v[228:231], v[84:87], v[100:103]
v_mfma_f32_16x16x32_bf16 v[104:107], v[224:227], v[88:91], v[104:107]
v_mfma_f32_16x16x32_bf16 v[108:111], v[228:231], v[88:91], v[108:111]
v_lshlrev_b32 v40, 16, v236
v_and_b32 v41, 0xffff0000, v236
v_lshlrev_b32 v42, 16, v237
v_and_b32 v43, 0xffff0000, v237
v_lshlrev_b32 v44, 16, v238
v_and_b32 v45, 0xffff0000, v238
v_lshlrev_b32 v46, 16, v239
v_and_b32 v47, 0xffff0000, v239
v_pk_mul_f32 v[120:121], v[96:97], v[40:41]
v_pk_mul_f32 v[112:113], v[104:105], v[40:41]
v_pk_mul_f32 v[122:123], v[98:99], v[42:43]
v_pk_mul_f32 v[114:115], v[106:107], v[42:43]
v_pk_mul_f32 v[124:125], v[100:101], v[44:45]
v_pk_mul_f32 v[116:117], v[108:109], v[44:45]
v_pk_mul_f32 v[126:127], v[102:103], v[46:47]
v_pk_mul_f32 v[118:119], v[110:111], v[46:47]
v_pk_fma_f32 v[112:113], v[96:97], v[32:33], v[112:113] neg_lo:[0,0,1] neg_hi:[0,0,1]
v_pk_fma_f32 v[120:121], v[104:105], v[32:33], v[120:121]
v_pk_fma_f32 v[114:115], v[98:99], v[34:35], v[114:115] neg_lo:[0,0,1] neg_hi:[0,0,1]
v_pk_fma_f32 v[122:123], v[106:107], v[34:35], v[122:123]
v_pk_fma_f32 v[116:117], v[100:101], v[36:37], v[116:117] neg_lo:[0,0,1] neg_hi:[0,0,1]
v_pk_fma_f32 v[124:125], v[108:109], v[36:37], v[124:125]
v_pk_fma_f32 v[118:119], v[102:103], v[38:39], v[118:119] neg_lo:[0,0,1] neg_hi:[0,0,1]
v_pk_fma_f32 v[126:127], v[110:111], v[38:39], v[126:127]
v_cvt_pk_bf16_f32 v80, v112, v113
v_cvt_pk_bf16_f32 v81, v114, v115
v_cvt_pk_bf16_f32 v82, v116, v117
v_cvt_pk_bf16_f32 v83, v118, v119
v_cvt_pk_bf16_f32 v84, v120, v121
v_cvt_pk_bf16_f32 v85, v122, v123
v_cvt_pk_bf16_f32 v86, v124, v125
v_cvt_pk_bf16_f32 v87, v126, v127
v_mfma_f32_16x16x32_bf16 v[96:99], v[80:83], a[248:251], 0
v_xor_b32 v88, 0x80008000, v84
v_xor_b32 v89, 0x80008000, v85
v_mfma_f32_16x16x32_bf16 v[100:103], v[80:83], a[252:255], 0
v_xor_b32 v90, 0x80008000, v86
v_xor_b32 v91, 0x80008000, v87
v_mfma_f32_16x16x32_bf16 v[104:107], v[80:83], v[224:227], 0
v_mfma_f32_16x16x32_bf16 v[108:111], v[80:83], v[228:231], 0
v_mfma_f32_16x16x32_bf16 v[96:99], v[88:91], v[224:227], v[96:99]
v_mfma_f32_16x16x32_bf16 v[100:103], v[88:91], v[228:231], v[100:103]
v_mfma_f32_16x16x32_bf16 v[104:107], v[84:87], a[248:251], v[104:107]
v_mfma_f32_16x16x32_bf16 v[108:111], v[84:87], a[252:255], v[108:111]
s_lshr_b32 s40, s32, 1
s_lshl_b32 s40, s40, 10
s_and_b32 s42, s32, 1
s_lshl3_add_u32 s40, s42, s40
v_add_u32 v240, s40, v1
v_pk_mul_f32 v[120:121], v[96:97], v[72:73]
s_nop 0
v_pk_mul_f32 v[112:113], v[104:105], v[72:73]
v_pk_mul_f32 v[122:123], v[98:99], v[74:75]
v_pk_mul_f32 v[114:115], v[106:107], v[74:75]
v_pk_mul_f32 v[124:125], v[100:101], v[76:77]
v_pk_mul_f32 v[116:117], v[108:109], v[76:77]
v_pk_mul_f32 v[126:127], v[102:103], v[78:79]
v_pk_mul_f32 v[118:119], v[110:111], v[78:79]
v_pk_fma_f32 v[112:113], v[96:97], v[64:65], v[112:113] neg_lo:[0,0,1] neg_hi:[0,0,1]
v_pk_fma_f32 v[120:121], v[104:105], v[64:65], v[120:121]
v_pk_fma_f32 v[114:115], v[98:99], v[66:67], v[114:115] neg_lo:[0,0,1] neg_hi:[0,0,1]
v_pk_fma_f32 v[122:123], v[106:107], v[66:67], v[122:123]
v_pk_fma_f32 v[116:117], v[100:101], v[68:69], v[116:117] neg_lo:[0,0,1] neg_hi:[0,0,1]
v_pk_fma_f32 v[124:125], v[108:109], v[68:69], v[124:125]
v_pk_fma_f32 v[118:119], v[102:103], v[70:71], v[118:119] neg_lo:[0,0,1] neg_hi:[0,0,1]
v_pk_fma_f32 v[126:127], v[110:111], v[70:71], v[126:127]
v_cvt_pk_bf16_f32 v80, v112, v113
v_cvt_pk_bf16_f32 v81, v114, v115
v_cvt_pk_bf16_f32 v82, v116, v117
v_cvt_pk_bf16_f32 v83, v118, v119
v_cvt_pk_bf16_f32 v84, v120, v121
v_cvt_pk_bf16_f32 v85, v122, v123
v_cvt_pk_bf16_f32 v86, v124, v125
v_cvt_pk_bf16_f32 v87, v126, v127
ds_write_b64 v240, v[80:81] offset:8192
ds_write_b64 v240, v[82:83] offset:10240
ds_write_b64 v240, v[84:85] offset:12288
ds_write_b64 v240, v[86:87] offset:14336
s_waitcnt lgkmcnt(0)
s_barrier
ds_read_b128 v[128:131], v1 offset:8192
ds_read_b128 v[136:139], v1 offset:10240
ds_read_b128 v[144:147], v1 offset:12288
ds_read_b128 v[152:155], v1 offset:14336
ds_read_b128 v[132:135], v1 offset:9216
ds_read_b128 v[140:143], v1 offset:11264
ds_read_b128 v[148:151], v1 offset:13312
ds_read_b128 v[156:159], v1 offset:15360
s_waitcnt lgkmcnt(7)
v_mfma_f32_16x16x32_bf16 v[96:99], v[128:131], a[224:227], 0
v_mfma_f32_16x16x32_bf16 v[104:107], v[128:131], a[232:235], 0
s_waitcnt lgkmcnt(6)
v_mfma_f32_16x16x32_bf16 v[100:103], v[136:139], a[224:227], 0
v_mfma_f32_16x16x32_bf16 v[108:111], v[136:139], a[232:235], 0
s_waitcnt lgkmcnt(5)
v_mfma_f32_16x16x32_bf16 v[96:99], v[144:147], a[240:243], v[96:99]
v_mfma_f32_16x16x32_bf16 v[104:107], v[144:147], a[224:227], v[104:107]
s_waitcnt lgkmcnt(4)
v_mfma_f32_16x16x32_bf16 v[100:103], v[152:155], a[240:243], v[100:103]
v_mfma_f32_16x16x32_bf16 v[108:111], v[152:155], a[224:227], v[108:111]
s_waitcnt lgkmcnt(3)
v_mfma_f32_16x16x32_bf16 v[96:99], v[132:135], a[228:231], v[96:99]
v_mfma_f32_16x16x32_bf16 v[104:107], v[132:135], a[236:239], v[104:107]
s_waitcnt lgkmcnt(2)
v_mfma_f32_16x16x32_bf16 v[100:103], v[140:143], a[228:231], v[100:103]
v_mfma_f32_16x16x32_bf16 v[108:111], v[140:143], a[236:239], v[108:111]
s_waitcnt lgkmcnt(1)
v_mfma_f32_16x16x32_bf16 v[96:99], v[148:151], a[244:247], v[96:99]
v_mfma_f32_16x16x32_bf16 v[104:107], v[148:151], a[228:231], v[104:107]
s_waitcnt lgkmcnt(0)
v_mfma_f32_16x16x32_bf16 v[100:103], v[156:159], a[244:247], v[100:103]
v_mfma_f32_16x16x32_bf16 v[108:111], v[156:159], a[228:231], v[108:111]
s_nop 3
v_cvt_pk_bf16_f32 v80, v96, v97
v_cvt_pk_bf16_f32 v81, v98, v99
s_nop 0
v_cvt_pk_bf16_f32 v82, v100, v101
v_cvt_pk_bf16_f32 v83, v102, v103
buffer_store_dwordx4 v[80:83], v1, s[20:23], s48 offen sc1
v_cvt_pk_bf16_f32 v84, v104, v105
v_cvt_pk_bf16_f32 v85, v106, v107
v_cvt_pk_bf16_f32 v86, v108, v109
v_cvt_pk_bf16_f32 v87, v110, v111
buffer_store_dwordx4 v[84:87], v244, s[20:23], s48 offen sc1
s_lshl_b32 s40, s32, 13
s_add_u32 s40, s40, 171008
s_waitcnt vmcnt(0)
s_mov_b64 exec, 1
buffer_store_dword v28, off, s[20:23], s40 sc1
s_mov_b64 exec, -1
L_aux2:
s_endpgm
L_codeend:
s_endpgm
.section .rodata,"a"
.p2align 6
.amdhsa_kernel gated_mix__spectral_gfnet__swiglu_ffn__prompt_kernel
  .amdhsa_next_free_vgpr 512
  .amdhsa_next_free_sgpr 102
  .amdhsa_accum_offset 256
  .amdhsa_group_segment_fixed_size 0
  .amdhsa_kernarg_size 88
  .amdhsa_user_sgpr_count 2
  .amdhsa_user_sgpr_kernarg_segment_ptr 1
  .amdhsa_system_sgpr_workgroup_id_x 1
  .amdhsa_float_denorm_mode_32 3
.end_amdhsa_kernel
```
